```python
import torch

def _softmax(x, axis=-1):
    return torch.softmax(x, dim=axis)
def _gelu(x):
    return torch.nn.functional.gelu(x, approximate="tanh")
def _silu(x):
    return torch.nn.functional.silu(x)
def _sigmoid(x):
    return torch.sigmoid(x)
def _layernorm(x, axis=-1, eps=1e-5):
    m = x.mean(dim=axis, keepdim=True)
    v = x.var(dim=axis, keepdim=True, unbiased=False)
    return (x - m) / torch.sqrt(v + eps)
def _scatter_add(tgt, idx, src, axis=0):
    return tgt.clone().index_add_(axis, idx, src)
def _segment_sum(src, seg, n):
    out = torch.zeros((n,) + src.shape[1:], dtype=src.dtype)
    return out.index_add_(0, seg, src)
def _pad(x, pw):
    flat = tuple(v for pair in reversed(pw) for v in pair)
    return torch.nn.functional.pad(x, flat)

kernel_name = 'concat_heads__gqa_block_cached__gqa_block_cached__near_ridge'

def setup_inputs():

    _w = (lambda a: (lambda t: t.to(torch.bfloat16) if t.is_floating_point() else t)(torch.as_tensor(a)))
    def _A_setup():
        B, Sq, D = 8, 80, 512
        Hq, Hkv, Sk, Dh = 32, 8, 512, 128
        assert Hq % Hkv == 0, (Hq, Hkv)
        return {
            "x": _w((lambda *s: torch.randn(*s, dtype=torch.bfloat16) * 0.8)(B, Sq, D)),
            "k_cache": _w((lambda *s: torch.randn(*s, dtype=torch.bfloat16) * 0.8)(B, Hkv, Sk, Dh)),
            "v_cache": _w((lambda *s: torch.randn(*s, dtype=torch.bfloat16) * 0.05)(B, Hkv, Sk, Dh)),
            "wq": _w((lambda *s: torch.randn(*s, dtype=torch.bfloat16) * 0.8)(D, Hq * Dh) * (D ** -0.5)),
            "wo": _w((lambda *s: torch.randn(*s, dtype=torch.bfloat16) * 0.05)(Hq * Dh, D) * ((Hq * Dh) ** -0.5)),
        }
    _A_in = _A_setup()

    def _B_setup():
        B, Sq, D = 8, 80, 512
        Hq, Hkv, Sk, Dh = 32, 8, 512, 128
        assert Hq % Hkv == 0, (Hq, Hkv)
        return {
            "x": _w((lambda *s: torch.randn(*s, dtype=torch.bfloat16) * 0.8)(B, Sq, D)),
            "k_cache": _w((lambda *s: torch.randn(*s, dtype=torch.bfloat16) * 0.8)(B, Hkv, Sk, Dh)),
            "v_cache": _w((lambda *s: torch.randn(*s, dtype=torch.bfloat16) * 0.05)(B, Hkv, Sk, Dh)),
            "wq": _w((lambda *s: torch.randn(*s, dtype=torch.bfloat16) * 0.8)(D, Hq * Dh) * (D ** -0.5)),
            "wo": _w((lambda *s: torch.randn(*s, dtype=torch.bfloat16) * 0.05)(Hq * Dh, D) * ((Hq * Dh) ** -0.5)),
        }
    _B_in = _B_setup()

    return {
        "A_x": _A_in["x"],
        "A_k_cache": _A_in["k_cache"],
        "A_v_cache": _A_in["v_cache"],
        "A_wq": _A_in["wq"],
        "A_wo": _A_in["wo"],
        "B_x": _B_in["x"],
        "B_k_cache": _B_in["k_cache"],
        "B_v_cache": _B_in["v_cache"],
        "B_wq": _B_in["wq"],
        "B_wo": _B_in["wo"],
    }

def reference(A_x, A_k_cache, A_v_cache, A_wq, A_wo, B_x, B_k_cache, B_v_cache, B_wq, B_wo):
    def _A_ref(x, k_cache, v_cache, wq, wo):
        B, Sq, D = x.shape
        Hq, Dh = 32, 128
        Hkv = k_cache.shape[1]
        rep = Hq // Hkv
        q = (lambda x, *d: x.permute(*d))((x @ wq).reshape(B, Sq, Hq, Dh), 0, 2, 1, 3)
        k = (lambda x, n, axis: torch.repeat_interleave(x, n, dim=axis))(k_cache, rep, axis=1)
        v = (lambda x, n, axis: torch.repeat_interleave(x, n, dim=axis))(v_cache, rep, axis=1)
        scores = torch.einsum("bhqd,bhkd->bhqk", q, k) * (Dh ** -0.5)
        p = _softmax(scores, axis=-1)
        o = torch.einsum("bhqk,bhkd->bhqd", p, v)
        return (lambda x, *d: x.permute(*d))(o, 0, 2, 1, 3).reshape(B, Sq, Hq * Dh) @ wo

    def _B_ref(x, k_cache, v_cache, wq, wo):
        B, Sq, D = x.shape
        Hq, Dh = 32, 128
        Hkv = k_cache.shape[1]
        rep = Hq // Hkv
        q = (lambda x, *d: x.permute(*d))((x @ wq).reshape(B, Sq, Hq, Dh), 0, 2, 1, 3)
        k = (lambda x, n, axis: torch.repeat_interleave(x, n, dim=axis))(k_cache, rep, axis=1)
        v = (lambda x, n, axis: torch.repeat_interleave(x, n, dim=axis))(v_cache, rep, axis=1)
        scores = torch.einsum("bhqd,bhkd->bhqk", q, k) * (Dh ** -0.5)
        p = _softmax(scores, axis=-1)
        o = torch.einsum("bhqk,bhkd->bhqd", p, v)
        return (lambda x, *d: x.permute(*d))(o, 0, 2, 1, 3).reshape(B, Sq, Hq * Dh) @ wo

    a = _A_ref(A_x, A_k_cache, A_v_cache, A_wq, A_wo)
    b = _B_ref(B_x, B_k_cache, B_v_cache, B_wq, B_wo)
    return torch.concatenate([a, b], axis=-1)
```

```asm
; @launch grid=(256,1,1) block=(256,1,1) lds=163840
.amdgcn_target "amdgcn-amd-amdhsa--gfx950"
.text
.globl concat_heads__gqa_block_cached__gqa_block_cached__near_ridge_kernel
.p2align 8
.type concat_heads__gqa_block_cached__gqa_block_cached__near_ridge_kernel,@function
concat_heads__gqa_block_cached__gqa_block_cached__near_ridge_kernel:
    s_cmp_ge_u32 s2, 0x100
    s_cbranch_scc1 L_exit
    s_getreg_b32 s82, hwreg(HW_REG_XCC_ID, 0, 3)
    s_sub_u32 s82, s82, s2
    s_and_b32 s82, s82, 7
    s_mov_b32 s79, 0
    s_mov_b32 s83, 0
L_restart:
    s_load_dwordx16 s[48:63], s[0:1], 0x0
    s_load_dwordx8 s[64:71], s[0:1], 0x40
    s_load_dwordx2 s[72:73], s[0:1], 0x60
    s_getpc_b64 s[74:75]
L_pc:
    s_cmp_lt_u32 s2, 64
    s_cbranch_scc1 L_nopf
    s_lshr_b32 s43, s2, 3
    s_mul_i32 s43, s43, 12
    v_mul_u32_u24 v1, 3, v0
    v_lshrrev_b32 v1, 6, v1
    v_add_lshl_u32 v1, v1, s43, 7
    v_add_u32 v1, L_main-L_pc-12288, v1
    v_min_u32 v2, L_code_end-L_pc-4, v1
    global_load_dword v33, v2, s[74:75]
L_nopf:
    v_lshrrev_b32 v2, 6, v0
    v_and_b32 v0, 63, v0
    v_readfirstlane_b32 s36, v2
    s_add_u32 s44, s2, s82
    s_bfe_u32 s76, s44, 0x10002
    s_lshr_b32 s43, s2, 3
    s_and_b32 s77, s43, 7
    s_lshr_b32 s43, s43, 3
    s_and_b32 s44, s44, 3
    s_lshl_b32 s44, s44, 2
    s_add_u32 s78, s43, s44
    s_and_b32 s35, s77, 3
    s_lshl_b32 s32, s35, 18
    s_lshr_b32 s33, s35, 2
    s_lshl_b32 s33, s33, 8
    s_and_b32 s35, s35, 3
    s_lshl_b32 s35, s35, 6
    s_lshl_b32 s37, s36, 12
    s_lshl_b32 s42, s36, 10
    s_and_b32 s44, s2, 0x80
    s_lshl_b32 s45, s44, 9
    s_or_b32 s3, s33, s45
    s_lshl_b32 s44, s44, 7
    s_add_u32 s74, s42, s44
    s_xor_b32 s75, s74, 0x4000
    v_lshrrev_b32 v1, 4, v0
    v_and_b32 v2, 15, v0
    s_lshl_b32 s43, s36, 2
    v_add_u32 v3, s43, v1
    v_xor_b32 v32, v2, v3
    v_lshlrev_b32 v32, 4, v32
    v_lshl_add_u32 v32, v3, 10, v32
    v_and_b32 v3, 1, v1
    v_lshlrev_b32 v3, 1, v3
    v_and_b32 v10, 7, v0
    v_xor_b32 v10, v10, v3
    v_lshlrev_b32 v10, 4, v10
    v_lshrrev_b32 v3, 3, v0
    v_lshl_add_u32 v10, v3, 13, v10
    s_lshl_b32 s43, s36, 7
    v_add_u32 v10, s43, v10
    v_xor_b32 v11, 64, v10
    v_add_u32 v12, 0x1f800, v10
    v_add_u32 v13, 0x2f400, v11
    v_add_u32 v11, 0xfc00, v11
    s_and_b32 s46, s2, 63
    s_lshl_b32 s46, s46, 20
    s_and_b32 s81, s2, 0xc3
    s_xor_b32 s81, s81, s36
    s_add_u32 s81, s81, s83
    s_lshl_b32 s43, s81, 20
    s_add_u32 s43, s43, 0xa0000
    v_lshrrev_b32 v3, 5, v0
    v_lshl_add_u32 v56, v3, 20, s43
    v_lshl_add_u32 v56, v0, 2, v56
    v_mov_b32 v60, 0
    s_movk_i32 s39, 0x2000
    s_mov_b32 s26, 0xa4000
    s_mov_b32 s27, 0x20000
    s_mul_i32 s45, s77, 81920
    s_lshl_b32 s43, s78, 9
    s_sub_u32 s44, 0x400000, s43
    s_cmp_eq_u32 s76, 0
    s_waitcnt lgkmcnt(0)
    s_cselect_b64 s[8:9], s[54:55], s[64:65]
    s_cselect_b64 s[4:5], s[48:49], s[58:59]
    s_cselect_b64 s[12:13], s[50:51], s[60:61]
    s_cselect_b64 s[16:17], s[52:53], s[62:63]
    s_cselect_b64 s[20:21], s[56:57], s[66:67]
    s_add_u32 s24, s72, s46
    s_addc_u32 s25, s73, 0
    buffer_store_dword v60, v56, s[24:27], 0 offen offset:0 sc1
    buffer_store_dword v60, v56, s[24:27], s39 offen offset:0 sc1
    s_cmp_lg_u32 s81, 0
    s_barrier
    s_cbranch_scc1 L_nowait
    s_waitcnt vmcnt(1)
L_nowait:
    s_add_u32 s8, s8, s43
    s_addc_u32 s9, s9, 0
    s_mov_b32 s10, s44
    s_mov_b32 s11, 0x20000
    s_add_u32 s4, s4, s45
    s_addc_u32 s5, s5, 0
    s_mov_b32 s6, 81920
    s_mov_b32 s7, 0x20000
    s_getreg_b32 s80, hwreg(HW_REG_IB_STS, 0, 4)
    s_add_u32 m0, s37, 0x14000
    s_xor_b32 s38, s32, 0x0
    buffer_load_dwordx4 v10, s[8:11], s38 offen offset:0 lds
    buffer_load_dwordx4 v11, s[8:11], s38 offen offset:1024 lds
    buffer_load_dwordx4 v12, s[8:11], s38 offen offset:2048 lds
    buffer_load_dwordx4 v13, s[8:11], s38 offen offset:3072 lds
    s_add_u32 m0, s74, 0x0
    s_xor_b32 s38, s3, 0x0
    buffer_load_dwordx4 v32, s[4:7], s38 offen offset:0 lds
    s_add_u32 m0, s42, 0x1000
    s_xor_b32 s38, s33, 0x4000
    buffer_load_dwordx4 v32, s[4:7], s38 offen offset:0 lds
    s_add_u32 m0, s42, 0x2000
    s_xor_b32 s38, s33, 0x8000
    buffer_load_dwordx4 v32, s[4:7], s38 offen offset:0 lds
    s_add_u32 m0, s42, 0x3000
    s_xor_b32 s38, s33, 0xc000
    buffer_load_dwordx4 v32, s[4:7], s38 offen offset:0 lds
    s_add_u32 m0, s75, 0x0
    s_xor_b32 s38, s3, 0x10000
    buffer_load_dwordx4 v32, s[4:7], s38 offen offset:0 lds
    s_barrier
    s_add_u32 m0, s37, 0x18000
    s_xor_b32 s38, s32, 0x40000
    buffer_load_dwordx4 v10, s[8:11], s38 offen offset:0 lds
    buffer_load_dwordx4 v11, s[8:11], s38 offen offset:1024 lds
    buffer_load_dwordx4 v12, s[8:11], s38 offen offset:2048 lds
    buffer_load_dwordx4 v13, s[8:11], s38 offen offset:3072 lds
    s_branch L_main
.p2align 12
L_main:
    s_mov_b64 exec, 0
    s_cmp_eq_u32 s36, 0
    s_cbranch_scc1 L_hop0
    s_cmp_eq_u32 s36, 1
    s_cbranch_scc1 L_hop2
    s_cmp_eq_u32 s36, 2
    s_cbranch_scc1 L_hop4
L_hop_ret:
    s_mov_b64 exec, -1
    s_cmp_eq_u32 s80, 0
    s_cselect_b32 s80, 1, 0
    v_xor_b32 v14, v2, v1
    v_lshlrev_b32 v14, 4, v14
    v_lshl_add_u32 v14, v2, 8, v14
    v_xor_b32 v14, s35, v14
    v_xor_b32 v15, 0x40, v14
    v_xor_b32 v16, 0x80, v14
    v_xor_b32 v17, 0xc0, v14
    v_and_b32 v3, 3, v0
    v_lshl_add_u32 v28, v3, 3, s37
    v_bfe_u32 v3, v0, 3, 2
    v_lshl_add_u32 v28, v3, 5, v28
    v_add_u32 v28, 0x14000, v28
    v_lshrrev_b32 v3, 2, v0
    v_lshl_add_u32 v34, v3, 7, v28
    v_bfe_u32 v3, v0, 2, 2
    v_lshl_add_u32 v3, v1, 3, v3
    v_lshl_add_u32 v28, v3, 7, v28
    v_xor_b32 v29, 0x20, v28
    v_xor_b32 v30, 0x40, v28
    v_xor_b32 v31, 0x60, v28
    s_add_u32 m0, s37, 0x1c000
    s_xor_b32 s38, s32, 0x80000
    buffer_load_dwordx4 v10, s[8:11], s38 offen offset:0 lds
    buffer_load_dwordx4 v11, s[8:11], s38 offen offset:1024 lds
    buffer_load_dwordx4 v12, s[8:11], s38 offen offset:2048 lds
    buffer_load_dwordx4 v13, s[8:11], s38 offen offset:3072 lds
    s_add_u32 m0, s37, 0x20000
    s_xor_b32 s38, s32, 0xc0000
    buffer_load_dwordx4 v10, s[8:11], s38 offen offset:0 lds
    buffer_load_dwordx4 v11, s[8:11], s38 offen offset:1024 lds
    buffer_load_dwordx4 v12, s[8:11], s38 offen offset:2048 lds
    buffer_load_dwordx4 v13, s[8:11], s38 offen offset:3072 lds
    s_waitcnt vmcnt(12)
    s_barrier
    ds_read_b64_tr_b16 a[0:1], v28 offset:0
    ds_read_b64_tr_b16 a[2:3], v28 offset:512
    ds_read_b128 a[16:19], v14 offset:0
    ds_read_b128 a[20:23], v14 offset:4096
    ds_read_b128 a[24:27], v14 offset:8192
    ds_read_b128 a[28:31], v14 offset:12288
    ds_read_b128 a[32:35], v14 offset:16384
    ds_read_b64_tr_b16 a[4:5], v29 offset:0
    ds_read_b64_tr_b16 a[6:7], v29 offset:512
    ds_read_b64_tr_b16 a[8:9], v30 offset:0
    ds_read_b64_tr_b16 a[10:11], v30 offset:512
    ds_read_b64_tr_b16 a[12:13], v31 offset:0
    ds_read_b64_tr_b16 a[14:15], v31 offset:512
    s_waitcnt lgkmcnt(10)
    v_mfma_f32_16x16x32_bf16 v[176:179], a[0:3], a[16:19], 0
    s_waitcnt lgkmcnt(0)
    s_add_u32 m0, s74, 0x5000
    s_xor_b32 s38, s3, 0x100
    v_mfma_f32_16x16x32_bf16 v[180:183], a[0:3], a[20:23], 0
    s_bfe_u32 s43, s2, 0x10002
    s_xor_b32 s80, s80, s43
    s_xor_b32 s80, s80, s76
    v_mfma_f32_16x16x32_bf16 v[184:187], a[0:3], a[24:27], 0
    s_lshl_b32 s43, s80, 13
    buffer_load_dwordx4 v32, s[4:7], s38 offen offset:0 lds
    v_mfma_f32_16x16x32_bf16 v[188:191], a[0:3], a[28:31], 0
    s_add_u32 m0, s42, 0x6000
    s_xor_b32 s38, s33, 0x4100
    s_lshl_b32 s44, s81, 20
    v_mfma_f32_16x16x32_bf16 v[192:195], a[0:3], a[32:35], 0
    s_add_u32 s43, s43, s44
    buffer_load_dwordx4 v32, s[4:7], s38 offen offset:0 lds
    v_mfma_f32_16x16x32_bf16 v[212:215], a[4:7], a[32:35], 0
    s_add_u32 m0, s42, 0x7000
    s_xor_b32 s38, s33, 0x8100
    s_add_u32 s43, s43, 0xa0080
    v_mfma_f32_16x16x32_bf16 v[208:211], a[4:7], a[28:31], 0
    buffer_load_dwordx4 v32, s[4:7], s38 offen offset:0 lds
    v_mfma_f32_16x16x32_bf16 v[204:207], a[4:7], a[24:27], 0
    s_add_u32 m0, s42, 0x8000
    s_xor_b32 s38, s33, 0xc100
    v_lshl_add_u32 v56, v0, 4, s43
    v_mfma_f32_16x16x32_bf16 v[200:203], a[4:7], a[20:23], 0
    buffer_load_dwordx4 v32, s[4:7], s38 offen offset:0 lds
    v_mfma_f32_16x16x32_bf16 v[196:199], a[4:7], a[16:19], 0
    s_add_u32 m0, s37, 0x14000
    s_xor_b32 s38, s32, 0x100000
    v_mov_b32 v64, 0
    v_mfma_f32_16x16x32_bf16 v[216:219], a[8:11], a[16:19], 0
    buffer_load_dwordx4 v10, s[8:11], s38 offen offset:0 lds
    v_mfma_f32_16x16x32_bf16 v[220:223], a[8:11], a[20:23], 0
    v_mov_b32 v65, 0
    v_mov_b32 v66, 0
    v_mfma_f32_16x16x32_bf16 v[224:227], a[8:11], a[24:27], 0
    buffer_load_dwordx4 v11, s[8:11], s38 offen offset:1024 lds
    v_mfma_f32_16x16x32_bf16 v[228:231], a[8:11], a[28:31], 0
    v_mov_b32 v67, 0
    v_mfma_f32_16x16x32_bf16 v[232:235], a[8:11], a[32:35], 0
    buffer_load_dwordx4 v12, s[8:11], s38 offen offset:2048 lds
    v_mfma_f32_16x16x32_bf16 v[252:255], a[12:15], a[32:35], 0
    buffer_store_dwordx4 v[64:67], v56, s[24:27], 0 offen offset:0 sc1
    v_mfma_f32_16x16x32_bf16 v[248:251], a[12:15], a[28:31], 0
    s_waitcnt vmcnt(16)
    ds_read_b64_tr_b16 a[36:37], v28 offset:16384
    ds_read_b64_tr_b16 a[38:39], v28 offset:16896
    v_mfma_f32_16x16x32_bf16 v[244:247], a[12:15], a[24:27], 0
    buffer_load_dwordx4 v13, s[8:11], s38 offen offset:3072 lds
    s_add_u32 m0, s75, 0x5000
    s_xor_b32 s38, s3, 0x10100
    v_mfma_f32_16x16x32_bf16 v[240:243], a[12:15], a[20:23], 0
    ds_read_b128 a[52:55], v15 offset:0
    ds_read_b128 a[56:59], v15 offset:4096
    v_mfma_f32_16x16x32_bf16 v[236:239], a[12:15], a[16:19], 0
    ds_read_b128 a[60:63], v15 offset:8192
    ds_read_b128 a[64:67], v15 offset:12288
    ds_read_b128 a[68:71], v15 offset:16384
    ds_read_b64_tr_b16 a[40:41], v29 offset:16384
    ds_read_b64_tr_b16 a[42:43], v29 offset:16896
    ds_read_b64_tr_b16 a[44:45], v30 offset:16384
    ds_read_b64_tr_b16 a[46:47], v30 offset:16896
    ds_read_b64_tr_b16 a[48:49], v31 offset:16384
    ds_read_b64_tr_b16 a[50:51], v31 offset:16896
    s_waitcnt lgkmcnt(0)
    buffer_load_dwordx4 v32, s[4:7], s38 offen offset:0 lds
    v_mfma_f32_16x16x32_bf16 v[176:179], a[36:39], a[52:55], v[176:179]
    s_add_u32 m0, s37, 0x18000
    buffer_store_dwordx4 v[64:67], v56, s[24:27], 0 offen offset:1024 sc1
    v_mfma_f32_16x16x32_bf16 v[180:183], a[36:39], a[56:59], v[180:183]
    s_xor_b32 s38, s32, 0x140000
    s_lshl_b32 s43, s77, 5
    v_mfma_f32_16x16x32_bf16 v[184:187], a[36:39], a[60:63], v[184:187]
    buffer_load_dwordx4 v10, s[8:11], s38 offen offset:0 lds
    v_mfma_f32_16x16x32_bf16 v[188:191], a[36:39], a[64:67], v[188:191]
    s_add_u32 s70, s70, s43
    s_addc_u32 s71, s71, 0
    s_lshl_b32 s43, s77, 1
    v_mfma_f32_16x16x32_bf16 v[192:195], a[36:39], a[68:71], v[192:195]
    s_add_u32 s43, s43, s76
    s_lshl_b32 s43, s43, 2
    s_add_u32 s43, s43, s36
    v_mfma_f32_16x16x32_bf16 v[212:215], a[40:43], a[68:71], v[212:215]
    s_lshl_b32 s43, s43, 20
    s_add_u32 s24, s72, s43
    s_addc_u32 s25, s73, 0
    v_mfma_f32_16x16x32_bf16 v[208:211], a[40:43], a[64:67], v[208:211]
    s_lshr_b32 s43, s78, 1
    s_lshl_b32 s44, s77, 3
    s_add_u32 s43, s43, s44
    v_mfma_f32_16x16x32_bf16 v[204:207], a[40:43], a[60:63], v[204:207]
    s_lshl_b32 s43, s43, 17
    buffer_load_dwordx4 v11, s[8:11], s38 offen offset:1024 lds
    v_mfma_f32_16x16x32_bf16 v[200:203], a[40:43], a[56:59], v[200:203]
    s_add_u32 s12, s12, s43
    s_addc_u32 s13, s13, 0
    s_mov_b32 s14, 0x20000
    v_mfma_f32_16x16x32_bf16 v[196:199], a[40:43], a[52:55], v[196:199]
    s_mov_b32 s15, 0x20000
    s_add_u32 s16, s16, s43
    s_addc_u32 s17, s17, 0
    v_mfma_f32_16x16x32_bf16 v[216:219], a[44:47], a[52:55], v[216:219]
    s_mov_b32 s18, 0x20000
    s_mov_b32 s19, 0x20000
    s_lshl_b32 s43, s78, 18
    v_mfma_f32_16x16x32_bf16 v[220:223], a[44:47], a[56:59], v[220:223]
    buffer_load_dwordx4 v12, s[8:11], s38 offen offset:2048 lds
    v_mfma_f32_16x16x32_bf16 v[224:227], a[44:47], a[60:63], v[224:227]
    s_add_u32 s20, s20, s43
    s_addc_u32 s21, s21, 0
    s_mov_b32 s22, 0x40000
    v_mfma_f32_16x16x32_bf16 v[228:231], a[44:47], a[64:67], v[228:231]
    s_mov_b32 s23, 0x20000
    s_lshr_b32 s43, s36, 1
    s_lshl_b32 s43, s43, 16
    v_mfma_f32_16x16x32_bf16 v[232:235], a[44:47], a[68:71], v[232:235]
    s_and_b32 s44, s36, 1
    s_lshl_b32 s45, s44, 12
    s_add_u32 s43, s43, s45
    v_mfma_f32_16x16x32_bf16 v[252:255], a[48:51], a[68:71], v[252:255]
    v_lshl_add_u32 v3, v1, 8, s43
    v_xor_b32 v4, v2, v1
    v_mfma_f32_16x16x32_bf16 v[248:251], a[48:51], a[64:67], v[248:251]
    s_waitcnt vmcnt(18)
    ds_read_b64_tr_b16 a[0:1], v28 offset:32768
    ds_read_b64_tr_b16 a[2:3], v28 offset:33280
    v_mfma_f32_16x16x32_bf16 v[244:247], a[48:51], a[60:63], v[244:247]
    buffer_load_dwordx4 v13, s[8:11], s38 offen offset:3072 lds
    v_mfma_f32_16x16x32_bf16 v[240:243], a[48:51], a[56:59], v[240:243]
    ds_read_b128 a[16:19], v16 offset:0
    ds_read_b128 a[20:23], v16 offset:4096
    v_mfma_f32_16x16x32_bf16 v[236:239], a[48:51], a[52:55], v[236:239]
    ds_read_b128 a[24:27], v16 offset:8192
    ds_read_b128 a[28:31], v16 offset:12288
    ds_read_b128 a[32:35], v16 offset:16384
    ds_read_b64_tr_b16 a[4:5], v29 offset:32768
    ds_read_b64_tr_b16 a[6:7], v29 offset:33280
    ds_read_b64_tr_b16 a[8:9], v30 offset:32768
    ds_read_b64_tr_b16 a[10:11], v30 offset:33280
    ds_read_b64_tr_b16 a[12:13], v31 offset:32768
    ds_read_b64_tr_b16 a[14:15], v31 offset:33280
    s_waitcnt lgkmcnt(0)
    v_mfma_f32_16x16x32_bf16 v[176:179], a[0:3], a[16:19], v[176:179]
    s_add_u32 m0, s37, 0x1c000
    s_xor_b32 s38, s32, 0x180000
    v_lshl_add_u32 v4, v4, 4, v3
    v_mfma_f32_16x16x32_bf16 v[180:183], a[0:3], a[20:23], v[180:183]
    v_xor_b32 v5, 0x40, v4
    v_xor_b32 v6, 0x80, v4
    v_mfma_f32_16x16x32_bf16 v[184:187], a[0:3], a[24:27], v[184:187]
    buffer_load_dwordx4 v10, s[8:11], s38 offen offset:0 lds
    v_mfma_f32_16x16x32_bf16 v[188:191], a[0:3], a[28:31], v[188:191]
    v_xor_b32 v7, 0xc0, v4
    v_lshlrev_b32 v8, 1, v1
    v_mfma_f32_16x16x32_bf16 v[192:195], a[0:3], a[32:35], v[192:195]
    v_xor_b32 v8, v2, v8
    v_lshl_add_u32 v8, v8, 4, v3
    v_mfma_f32_16x16x32_bf16 v[212:215], a[4:7], a[32:35], v[212:215]
    v_xor_b32 v9, 0x80, v8
    v_and_b32 v3, 31, v0
    v_mfma_f32_16x16x32_bf16 v[208:211], a[4:7], a[28:31], v[208:211]
    v_lshl_add_u32 v60, v3, 7, s43
    v_lshrrev_b32 v3, 5, v0
    v_mfma_f32_16x16x32_bf16 v[204:207], a[4:7], a[24:27], v[204:207]
    buffer_load_dwordx4 v11, s[8:11], s38 offen offset:1024 lds
    v_mfma_f32_16x16x32_bf16 v[200:203], a[4:7], a[20:23], v[200:203]
    v_lshl_add_u32 v60, v3, 20, v60
    s_lshl_b32 s45, s44, 2
    v_mfma_f32_16x16x32_bf16 v[196:199], a[4:7], a[16:19], v[196:199]
    s_lshl_b32 s46, s44, 13
    s_add_u32 s46, s46, 0x8000
    v_lshrrev_b32 v3, 2, v0
    v_mfma_f32_16x16x32_bf16 v[216:219], a[8:11], a[16:19], v[216:219]
    v_and_b32 v18, 7, v3
    v_xor_b32 v18, s45, v18
    v_mfma_f32_16x16x32_bf16 v[220:223], a[8:11], a[20:23], v[220:223]
    buffer_load_dwordx4 v12, s[8:11], s38 offen offset:2048 lds
    v_mfma_f32_16x16x32_bf16 v[224:227], a[8:11], a[24:27], v[224:227]
    v_lshlrev_b32 v18, 5, v18
    v_lshl_add_u32 v18, v3, 8, v18
    v_mfma_f32_16x16x32_bf16 v[228:231], a[8:11], a[28:31], v[228:231]
    v_and_b32 v3, 3, v0
    v_lshl_add_u32 v18, v3, 3, v18
    v_mfma_f32_16x16x32_bf16 v[232:235], a[8:11], a[32:35], v[232:235]
    v_add_u32 v18, s46, v18
    v_xor_b32 v19, 0x20, v18
    v_mfma_f32_16x16x32_bf16 v[252:255], a[12:15], a[32:35], v[252:255]
    v_xor_b32 v20, 0x40, v18
    v_xor_b32 v21, 0x60, v18
    v_mfma_f32_16x16x32_bf16 v[248:251], a[12:15], a[28:31], v[248:251]
    s_waitcnt vmcnt(18)
    ds_read_b64_tr_b16 a[36:37], v28 offset:49152
    ds_read_b64_tr_b16 a[38:39], v28 offset:49664
    v_mfma_f32_16x16x32_bf16 v[244:247], a[12:15], a[24:27], v[244:247]
    buffer_load_dwordx4 v13, s[8:11], s38 offen offset:3072 lds
    v_mfma_f32_16x16x32_bf16 v[240:243], a[12:15], a[20:23], v[240:243]
    ds_read_b128 a[52:55], v17 offset:0
    ds_read_b128 a[56:59], v17 offset:4096
    v_mfma_f32_16x16x32_bf16 v[236:239], a[12:15], a[16:19], v[236:239]
    ds_read_b128 a[60:63], v17 offset:8192
    ds_read_b128 a[64:67], v17 offset:12288
    ds_read_b128 a[68:71], v17 offset:16384
    ds_read_b64_tr_b16 a[40:41], v29 offset:49152
    ds_read_b64_tr_b16 a[42:43], v29 offset:49664
    ds_read_b64_tr_b16 a[44:45], v30 offset:49152
    ds_read_b64_tr_b16 a[46:47], v30 offset:49664
    ds_read_b64_tr_b16 a[48:49], v31 offset:49152
    ds_read_b64_tr_b16 a[50:51], v31 offset:49664
    s_waitcnt lgkmcnt(0)
    v_mfma_f32_16x16x32_bf16 v[176:179], a[36:39], a[52:55], v[176:179]
    s_add_u32 m0, s37, 0x20000
    s_xor_b32 s38, s32, 0x1c0000
    v_xor_b32 v22, 0x80, v18
    v_mfma_f32_16x16x32_bf16 v[180:183], a[36:39], a[56:59], v[180:183]
    v_xor_b32 v23, 0xa0, v18
    v_xor_b32 v24, 0xc0, v18
    v_mfma_f32_16x16x32_bf16 v[184:187], a[36:39], a[60:63], v[184:187]
    buffer_load_dwordx4 v10, s[8:11], s38 offen offset:0 lds
    v_mfma_f32_16x16x32_bf16 v[188:191], a[36:39], a[64:67], v[188:191]
    v_xor_b32 v25, 0xe0, v18
    s_mul_i32 s43, s36, 10240
    v_mfma_f32_16x16x32_bf16 v[192:195], a[36:39], a[68:71], v[192:195]
    v_lshrrev_b32 v3, 1, v1
    v_lshl_add_u32 v27, v3, 8, s43
    v_mfma_f32_16x16x32_bf16 v[212:215], a[40:43], a[68:71], v[212:215]
    buffer_load_dwordx4 v11, s[8:11], s38 offen offset:1024 lds
    v_mfma_f32_16x16x32_bf16 v[208:211], a[40:43], a[64:67], v[208:211]
    v_lshl_add_u32 v27, v2, 4, v27
    v_and_b32 v3, 1, v1
    v_mfma_f32_16x16x32_bf16 v[204:207], a[40:43], a[60:63], v[204:207]
    v_lshl_add_u32 v27, v3, 3, v27
    s_mul_i32 s43, s36, 10240
    v_mfma_f32_16x16x32_bf16 v[200:203], a[40:43], a[56:59], v[200:203]
    buffer_load_dwordx4 v12, s[8:11], s38 offen offset:2048 lds
    v_mfma_f32_16x16x32_bf16 v[196:199], a[40:43], a[52:55], v[196:199]
    v_lshl_add_u32 v26, v0, 4, s43
    s_mov_b32 s40, 0x3e0293ee
    v_mfma_f32_16x16x32_bf16 v[216:219], a[44:47], a[52:55], v[216:219]
    s_mov_b32 s41, 0x3e0293ee
    v_mov_b32 v3, 0x3f803f80
    v_accvgpr_write_b32 a180, v3
    v_mfma_f32_16x16x32_bf16 v[220:223], a[44:47], a[56:59], v[220:223]
    buffer_load_dwordx4 v13, s[8:11], s38 offen offset:3072 lds
    v_mfma_f32_16x16x32_bf16 v[224:227], a[44:47], a[60:63], v[224:227]
    s_add_u32 m0, s74, 0xa000
    s_xor_b32 s38, s3, 0x200
    v_accvgpr_write_b32 a181, v3
    v_mfma_f32_16x16x32_bf16 v[228:231], a[44:47], a[64:67], v[228:231]
    v_accvgpr_write_b32 a182, v3
    v_accvgpr_write_b32 a183, v3
    v_mfma_f32_16x16x32_bf16 v[232:235], a[44:47], a[68:71], v[232:235]
    buffer_load_dwordx4 v32, s[4:7], s38 offen offset:0 lds
    v_mfma_f32_16x16x32_bf16 v[252:255], a[48:51], a[68:71], v[252:255]
    s_add_u32 m0, s42, 0xb000
    s_xor_b32 s38, s33, 0x4200
    v_mov_b32 v36, 0
    v_mfma_f32_16x16x32_bf16 v[248:251], a[48:51], a[64:67], v[248:251]
    s_waitcnt vmcnt(14)
    s_barrier
    ds_read_b64_tr_b16 a[0:1], v28 offset:0
    v_mfma_f32_16x16x32_bf16 v[244:247], a[48:51], a[60:63], v[244:247]
    ds_read_b64_tr_b16 a[2:3], v28 offset:512
    ds_read_b128 a[16:19], v14 offset:20480
    v_mfma_f32_16x16x32_bf16 v[240:243], a[48:51], a[56:59], v[240:243]
    buffer_load_dwordx4 v32, s[4:7], s38 offen offset:0 lds
    v_mfma_f32_16x16x32_bf16 v[236:239], a[48:51], a[52:55], v[236:239]
    ds_read_b128 a[20:23], v14 offset:24576
    ds_read_b128 a[24:27], v14 offset:28672
    ds_read_b128 a[28:31], v14 offset:32768
    ds_read_b128 a[32:35], v14 offset:36864
    ds_read_b64_tr_b16 a[4:5], v29 offset:0
    ds_read_b64_tr_b16 a[6:7], v29 offset:512
    ds_read_b64_tr_b16 a[8:9], v30 offset:0
    ds_read_b64_tr_b16 a[10:11], v30 offset:512
    ds_read_b64_tr_b16 a[12:13], v31 offset:0
    ds_read_b64_tr_b16 a[14:15], v31 offset:512
    s_waitcnt lgkmcnt(0)
    v_mfma_f32_16x16x32_bf16 v[176:179], a[0:3], a[16:19], v[176:179]
    s_add_u32 m0, s42, 0xc000
    s_xor_b32 s38, s33, 0x8200
    v_mov_b32 v37, 0
    v_mfma_f32_16x16x32_bf16 v[180:183], a[0:3], a[20:23], v[180:183]
    v_mov_b32 v38, 0
    v_mov_b32 v39, 0
    v_mfma_f32_16x16x32_bf16 v[184:187], a[0:3], a[24:27], v[184:187]
    buffer_load_dwordx4 v32, s[4:7], s38 offen offset:0 lds
    v_mfma_f32_16x16x32_bf16 v[188:191], a[0:3], a[28:31], v[188:191]
    s_add_u32 m0, s42, 0xd000
    s_xor_b32 s38, s33, 0xc200
    v_mov_b32 v40, 0
    v_mfma_f32_16x16x32_bf16 v[192:195], a[0:3], a[32:35], v[192:195]
    v_mov_b32 v41, 0
    v_mov_b32 v42, 0
    v_mfma_f32_16x16x32_bf16 v[212:215], a[4:7], a[32:35], v[212:215]
    buffer_load_dwordx4 v32, s[4:7], s38 offen offset:0 lds
    v_mfma_f32_16x16x32_bf16 v[208:211], a[4:7], a[28:31], v[208:211]
    s_add_u32 m0, s37, 0x14000
    s_xor_b32 s38, s32, 0x200000
    v_mov_b32 v43, 0
    v_mfma_f32_16x16x32_bf16 v[204:207], a[4:7], a[24:27], v[204:207]
    v_mov_b32 v44, 0
    v_mov_b32 v45, 0
    v_mfma_f32_16x16x32_bf16 v[200:203], a[4:7], a[20:23], v[200:203]
    buffer_load_dwordx4 v10, s[8:11], s38 offen offset:0 lds
    v_mfma_f32_16x16x32_bf16 v[196:199], a[4:7], a[16:19], v[196:199]
    v_mov_b32 v46, 0
    v_mov_b32 v47, 0
    v_mfma_f32_16x16x32_bf16 v[216:219], a[8:11], a[16:19], v[216:219]
    buffer_load_dwordx4 v11, s[8:11], s38 offen offset:1024 lds
    v_mfma_f32_16x16x32_bf16 v[220:223], a[8:11], a[20:23], v[220:223]
    v_mov_b32 v48, 0
    v_mov_b32 v49, 0
    v_mfma_f32_16x16x32_bf16 v[224:227], a[8:11], a[24:27], v[224:227]
    v_mov_b32 v50, 0
    v_mov_b32 v51, 0
    v_mfma_f32_16x16x32_bf16 v[228:231], a[8:11], a[28:31], v[228:231]
    buffer_load_dwordx4 v12, s[8:11], s38 offen offset:2048 lds
    v_mfma_f32_16x16x32_bf16 v[232:235], a[8:11], a[32:35], v[232:235]
    v_mov_b32 v52, 0
    v_mov_b32 v53, 0
    v_mfma_f32_16x16x32_bf16 v[252:255], a[12:15], a[32:35], v[252:255]
    buffer_load_dwordx4 v13, s[8:11], s38 offen offset:3072 lds
    v_mfma_f32_16x16x32_bf16 v[248:251], a[12:15], a[28:31], v[248:251]
    s_waitcnt vmcnt(16)
    ds_read_b64_tr_b16 a[36:37], v28 offset:16384
    ds_read_b64_tr_b16 a[38:39], v28 offset:16896
    v_mfma_f32_16x16x32_bf16 v[244:247], a[12:15], a[24:27], v[244:247]
    s_add_u32 m0, s75, 0xa000
    s_xor_b32 s38, s3, 0x10200
    ds_read_b128 a[52:55], v15 offset:20480
    v_mfma_f32_16x16x32_bf16 v[240:243], a[12:15], a[20:23], v[240:243]
    ds_read_b128 a[56:59], v15 offset:24576
    ds_read_b128 a[60:63], v15 offset:28672
    v_mfma_f32_16x16x32_bf16 v[236:239], a[12:15], a[16:19], v[236:239]
    ds_read_b128 a[64:67], v15 offset:32768
    ds_read_b128 a[68:71], v15 offset:36864
    ds_read_b64_tr_b16 a[40:41], v29 offset:16384
    ds_read_b64_tr_b16 a[42:43], v29 offset:16896
    ds_read_b64_tr_b16 a[44:45], v30 offset:16384
    ds_read_b64_tr_b16 a[46:47], v30 offset:16896
    ds_read_b64_tr_b16 a[48:49], v31 offset:16384
    ds_read_b64_tr_b16 a[50:51], v31 offset:16896
    s_waitcnt lgkmcnt(0)
    buffer_load_dwordx4 v32, s[4:7], s38 offen offset:0 lds
    v_mfma_f32_16x16x32_bf16 v[176:179], a[36:39], a[52:55], v[176:179]
    s_add_u32 m0, s37, 0x18000
    s_xor_b32 s38, s32, 0x240000
    v_mov_b32 v54, 0
    v_mfma_f32_16x16x32_bf16 v[180:183], a[36:39], a[56:59], v[180:183]
    v_mov_b32 v55, 0
    s_mov_b32 s34, 0
    v_mfma_f32_16x16x32_bf16 v[184:187], a[36:39], a[60:63], v[184:187]
    buffer_load_dwordx4 v10, s[8:11], s38 offen offset:0 lds
    v_mfma_f32_16x16x32_bf16 v[188:191], a[36:39], a[64:67], v[188:191]
    v_mfma_f32_16x16x32_bf16 v[192:195], a[36:39], a[68:71], v[192:195]
    v_mfma_f32_16x16x32_bf16 v[212:215], a[40:43], a[68:71], v[212:215]
    v_mfma_f32_16x16x32_bf16 v[208:211], a[40:43], a[64:67], v[208:211]
    v_mfma_f32_16x16x32_bf16 v[204:207], a[40:43], a[60:63], v[204:207]
    buffer_load_dwordx4 v11, s[8:11], s38 offen offset:1024 lds
    v_mfma_f32_16x16x32_bf16 v[200:203], a[40:43], a[56:59], v[200:203]
    v_mfma_f32_16x16x32_bf16 v[196:199], a[40:43], a[52:55], v[196:199]
    v_mfma_f32_16x16x32_bf16 v[216:219], a[44:47], a[52:55], v[216:219]
    v_mfma_f32_16x16x32_bf16 v[220:223], a[44:47], a[56:59], v[220:223]
    buffer_load_dwordx4 v12, s[8:11], s38 offen offset:2048 lds
    v_mfma_f32_16x16x32_bf16 v[224:227], a[44:47], a[60:63], v[224:227]
    v_mfma_f32_16x16x32_bf16 v[228:231], a[44:47], a[64:67], v[228:231]
    v_mfma_f32_16x16x32_bf16 v[232:235], a[44:47], a[68:71], v[232:235]
    v_mfma_f32_16x16x32_bf16 v[252:255], a[48:51], a[68:71], v[252:255]
    v_mfma_f32_16x16x32_bf16 v[248:251], a[48:51], a[64:67], v[248:251]
    s_waitcnt vmcnt(16)
    ds_read_b64_tr_b16 a[0:1], v28 offset:32768
    ds_read_b64_tr_b16 a[2:3], v28 offset:33280
    v_mfma_f32_16x16x32_bf16 v[244:247], a[48:51], a[60:63], v[244:247]
    buffer_load_dwordx4 v13, s[8:11], s38 offen offset:3072 lds
    v_mfma_f32_16x16x32_bf16 v[240:243], a[48:51], a[56:59], v[240:243]
    ds_read_b128 a[16:19], v16 offset:20480
    ds_read_b128 a[20:23], v16 offset:24576
    v_mfma_f32_16x16x32_bf16 v[236:239], a[48:51], a[52:55], v[236:239]
    ds_read_b128 a[24:27], v16 offset:28672
    ds_read_b128 a[28:31], v16 offset:32768
    ds_read_b128 a[32:35], v16 offset:36864
    ds_read_b64_tr_b16 a[4:5], v29 offset:32768
    ds_read_b64_tr_b16 a[6:7], v29 offset:33280
    ds_read_b64_tr_b16 a[8:9], v30 offset:32768
    ds_read_b64_tr_b16 a[10:11], v30 offset:33280
    ds_read_b64_tr_b16 a[12:13], v31 offset:32768
    ds_read_b64_tr_b16 a[14:15], v31 offset:33280
    s_waitcnt lgkmcnt(0)
    v_mfma_f32_16x16x32_bf16 v[176:179], a[0:3], a[16:19], v[176:179]
    s_add_u32 m0, s37, 0x1c000
    s_xor_b32 s38, s32, 0x280000
    v_mfma_f32_16x16x32_bf16 v[180:183], a[0:3], a[20:23], v[180:183]
    v_mfma_f32_16x16x32_bf16 v[184:187], a[0:3], a[24:27], v[184:187]
    buffer_load_dwordx4 v10, s[8:11], s38 offen offset:0 lds
    v_mfma_f32_16x16x32_bf16 v[188:191], a[0:3], a[28:31], v[188:191]
    v_mfma_f32_16x16x32_bf16 v[192:195], a[0:3], a[32:35], v[192:195]
    v_mfma_f32_16x16x32_bf16 v[212:215], a[4:7], a[32:35], v[212:215]
    v_mfma_f32_16x16x32_bf16 v[208:211], a[4:7], a[28:31], v[208:211]
    v_mfma_f32_16x16x32_bf16 v[204:207], a[4:7], a[24:27], v[204:207]
    buffer_load_dwordx4 v11, s[8:11], s38 offen offset:1024 lds
    v_mfma_f32_16x16x32_bf16 v[200:203], a[4:7], a[20:23], v[200:203]
    v_mfma_f32_16x16x32_bf16 v[196:199], a[4:7], a[16:19], v[196:199]
    v_mfma_f32_16x16x32_bf16 v[216:219], a[8:11], a[16:19], v[216:219]
    v_mfma_f32_16x16x32_bf16 v[220:223], a[8:11], a[20:23], v[220:223]
    buffer_load_dwordx4 v12, s[8:11], s38 offen offset:2048 lds
    v_mfma_f32_16x16x32_bf16 v[224:227], a[8:11], a[24:27], v[224:227]
    v_mfma_f32_16x16x32_bf16 v[228:231], a[8:11], a[28:31], v[228:231]
    v_mfma_f32_16x16x32_bf16 v[232:235], a[8:11], a[32:35], v[232:235]
    v_mfma_f32_16x16x32_bf16 v[252:255], a[12:15], a[32:35], v[252:255]
    v_mfma_f32_16x16x32_bf16 v[248:251], a[12:15], a[28:31], v[248:251]
    s_waitcnt vmcnt(16)
    ds_read_b64_tr_b16 a[36:37], v28 offset:49152
    ds_read_b64_tr_b16 a[38:39], v28 offset:49664
    v_mfma_f32_16x16x32_bf16 v[244:247], a[12:15], a[24:27], v[244:247]
    buffer_load_dwordx4 v13, s[8:11], s38 offen offset:3072 lds
    v_mfma_f32_16x16x32_bf16 v[240:243], a[12:15], a[20:23], v[240:243]
    ds_read_b128 a[52:55], v17 offset:20480
    ds_read_b128 a[56:59], v17 offset:24576
    v_mfma_f32_16x16x32_bf16 v[236:239], a[12:15], a[16:19], v[236:239]
    ds_read_b128 a[60:63], v17 offset:28672
    ds_read_b128 a[64:67], v17 offset:32768
    ds_read_b128 a[68:71], v17 offset:36864
    ds_read_b64_tr_b16 a[40:41], v29 offset:49152
    ds_read_b64_tr_b16 a[42:43], v29 offset:49664
    ds_read_b64_tr_b16 a[44:45], v30 offset:49152
    ds_read_b64_tr_b16 a[46:47], v30 offset:49664
    ds_read_b64_tr_b16 a[48:49], v31 offset:49152
    ds_read_b64_tr_b16 a[50:51], v31 offset:49664
    s_waitcnt lgkmcnt(0)
    v_mfma_f32_16x16x32_bf16 v[176:179], a[36:39], a[52:55], v[176:179]
    s_add_u32 m0, s37, 0x20000
    s_xor_b32 s38, s32, 0x2c0000
    v_mfma_f32_16x16x32_bf16 v[180:183], a[36:39], a[56:59], v[180:183]
    v_mfma_f32_16x16x32_bf16 v[184:187], a[36:39], a[60:63], v[184:187]
    buffer_load_dwordx4 v10, s[8:11], s38 offen offset:0 lds
    v_mfma_f32_16x16x32_bf16 v[188:191], a[36:39], a[64:67], v[188:191]
    v_mfma_f32_16x16x32_bf16 v[192:195], a[36:39], a[68:71], v[192:195]
    v_mfma_f32_16x16x32_bf16 v[212:215], a[40:43], a[68:71], v[212:215]
    buffer_load_dwordx4 v11, s[8:11], s38 offen offset:1024 lds
    v_mfma_f32_16x16x32_bf16 v[208:211], a[40:43], a[64:67], v[208:211]
    v_mfma_f32_16x16x32_bf16 v[204:207], a[40:43], a[60:63], v[204:207]
    v_mfma_f32_16x16x32_bf16 v[200:203], a[40:43], a[56:59], v[200:203]
    buffer_load_dwordx4 v12, s[8:11], s38 offen offset:2048 lds
    v_mfma_f32_16x16x32_bf16 v[196:199], a[40:43], a[52:55], v[196:199]
    v_mfma_f32_16x16x32_bf16 v[216:219], a[44:47], a[52:55], v[216:219]
    v_mfma_f32_16x16x32_bf16 v[220:223], a[44:47], a[56:59], v[220:223]
    buffer_load_dwordx4 v13, s[8:11], s38 offen offset:3072 lds
    v_mfma_f32_16x16x32_bf16 v[224:227], a[44:47], a[60:63], v[224:227]
    s_add_u32 m0, s74, 0xf000
    s_xor_b32 s38, s3, 0x300
    v_mfma_f32_16x16x32_bf16 v[228:231], a[44:47], a[64:67], v[228:231]
    v_mfma_f32_16x16x32_bf16 v[232:235], a[44:47], a[68:71], v[232:235]
    buffer_load_dwordx4 v32, s[4:7], s38 offen offset:0 lds
    v_mfma_f32_16x16x32_bf16 v[252:255], a[48:51], a[68:71], v[252:255]
    s_add_u32 m0, s42, 0x10000
    s_xor_b32 s38, s33, 0x4300
    v_mfma_f32_16x16x32_bf16 v[248:251], a[48:51], a[64:67], v[248:251]
    s_waitcnt vmcnt(13)
    s_barrier
    ds_read_b64_tr_b16 a[0:1], v28 offset:0
    v_mfma_f32_16x16x32_bf16 v[244:247], a[48:51], a[60:63], v[244:247]
    ds_read_b64_tr_b16 a[2:3], v28 offset:512
    ds_read_b128 a[16:19], v14 offset:40960
    v_mfma_f32_16x16x32_bf16 v[240:243], a[48:51], a[56:59], v[240:243]
    buffer_load_dwordx4 v32, s[4:7], s38 offen offset:0 lds
    v_mfma_f32_16x16x32_bf16 v[236:239], a[48:51], a[52:55], v[236:239]
    ds_read_b128 a[20:23], v14 offset:45056
    ds_read_b128 a[24:27], v14 offset:49152
    ds_read_b128 a[28:31], v14 offset:53248
    ds_read_b128 a[32:35], v14 offset:57344
    ds_read_b64_tr_b16 a[4:5], v29 offset:0
    ds_read_b64_tr_b16 a[6:7], v29 offset:512
    ds_read_b64_tr_b16 a[8:9], v30 offset:0
    ds_read_b64_tr_b16 a[10:11], v30 offset:512
    ds_read_b64_tr_b16 a[12:13], v31 offset:0
    ds_read_b64_tr_b16 a[14:15], v31 offset:512
    s_waitcnt lgkmcnt(0)
    v_mfma_f32_16x16x32_bf16 v[176:179], a[0:3], a[16:19], v[176:179]
    s_add_u32 m0, s42, 0x11000
    s_xor_b32 s38, s33, 0x8300
    v_mfma_f32_16x16x32_bf16 v[180:183], a[0:3], a[20:23], v[180:183]
    v_mfma_f32_16x16x32_bf16 v[184:187], a[0:3], a[24:27], v[184:187]
    buffer_load_dwordx4 v32, s[4:7], s38 offen offset:0 lds
    v_mfma_f32_16x16x32_bf16 v[188:191], a[0:3], a[28:31], v[188:191]
    s_add_u32 m0, s42, 0x12000
    s_xor_b32 s38, s33, 0xc300
    v_mfma_f32_16x16x32_bf16 v[192:195], a[0:3], a[32:35], v[192:195]
    v_mfma_f32_16x16x32_bf16 v[212:215], a[4:7], a[32:35], v[212:215]
    buffer_load_dwordx4 v32, s[4:7], s38 offen offset:0 lds
    v_mfma_f32_16x16x32_bf16 v[208:211], a[4:7], a[28:31], v[208:211]
    s_waitcnt vmcnt(12)
    s_add_u32 m0, s37, 0x14000
    s_xor_b32 s38, s32, 0x300000
    v_mfma_f32_16x16x32_bf16 v[204:207], a[4:7], a[24:27], v[204:207]
    ds_read_b64_tr_b16 a[36:37], v28 offset:16384
    ds_read_b64_tr_b16 a[38:39], v28 offset:16896
    v_mfma_f32_16x16x32_bf16 v[200:203], a[4:7], a[20:23], v[200:203]
    buffer_load_dwordx4 v10, s[8:11], s38 offen offset:0 lds
    v_mfma_f32_16x16x32_bf16 v[196:199], a[4:7], a[16:19], v[196:199]
    ds_read_b128 a[52:55], v15 offset:40960
    ds_read_b128 a[56:59], v15 offset:45056
    v_mfma_f32_16x16x32_bf16 v[216:219], a[8:11], a[16:19], v[216:219]
    buffer_load_dwordx4 v11, s[8:11], s38 offen offset:1024 lds
    v_mfma_f32_16x16x32_bf16 v[220:223], a[8:11], a[20:23], v[220:223]
    ds_read_b128 a[60:63], v15 offset:49152
    ds_read_b128 a[64:67], v15 offset:53248
    v_mfma_f32_16x16x32_bf16 v[224:227], a[8:11], a[24:27], v[224:227]
    ds_read_b128 a[68:71], v15 offset:57344
    ds_read_b64_tr_b16 a[40:41], v29 offset:16384
    v_mfma_f32_16x16x32_bf16 v[228:231], a[8:11], a[28:31], v[228:231]
L_hop0:
    s_cbranch_execz L_hop1
    ds_read_b64_tr_b16 a[42:43], v29 offset:16896
    ds_read_b64_tr_b16 a[44:45], v30 offset:16384
    v_mfma_f32_16x16x32_bf16 v[232:235], a[8:11], a[32:35], v[232:235]
    buffer_load_dwordx4 v12, s[8:11], s38 offen offset:2048 lds
    v_mfma_f32_16x16x32_bf16 v[252:255], a[12:15], a[32:35], v[252:255]
    ds_read_b64_tr_b16 a[46:47], v30 offset:16896
    ds_read_b64_tr_b16 a[48:49], v31 offset:16384
    ds_read_b64_tr_b16 a[50:51], v31 offset:16896
    v_mfma_f32_16x16x32_bf16 v[248:251], a[12:15], a[28:31], v[248:251]
    buffer_load_dwordx4 v13, s[8:11], s38 offen offset:3072 lds
    v_mfma_f32_16x16x32_bf16 v[244:247], a[12:15], a[24:27], v[244:247]
    s_add_u32 m0, s75, 0xf000
    s_xor_b32 s38, s3, 0x10300
    v_mfma_f32_16x16x32_bf16 v[240:243], a[12:15], a[20:23], v[240:243]
    buffer_load_dwordx4 v32, s[4:7], s38 offen offset:0 lds
    v_mfma_f32_16x16x32_bf16 v[236:239], a[12:15], a[16:19], v[236:239]
    s_waitcnt lgkmcnt(0)
    s_add_u32 m0, s37, 0x18000
    v_mfma_f32_16x16x32_bf16 v[176:179], a[36:39], a[52:55], v[176:179]
    s_xor_b32 s38, s32, 0x340000
    v_mfma_f32_16x16x32_bf16 v[180:183], a[36:39], a[56:59], v[180:183]
    v_mfma_f32_16x16x32_bf16 v[184:187], a[36:39], a[60:63], v[184:187]
    buffer_load_dwordx4 v10, s[8:11], s38 offen offset:0 lds
    v_mfma_f32_16x16x32_bf16 v[188:191], a[36:39], a[64:67], v[188:191]
    v_mfma_f32_16x16x32_bf16 v[192:195], a[36:39], a[68:71], v[192:195]
    v_mfma_f32_16x16x32_bf16 v[212:215], a[40:43], a[68:71], v[212:215]
    v_mfma_f32_16x16x32_bf16 v[208:211], a[40:43], a[64:67], v[208:211]
    s_waitcnt vmcnt(14)
    ds_read_b64_tr_b16 a[0:1], v28 offset:32768
    ds_read_b64_tr_b16 a[2:3], v28 offset:33280
    v_mfma_f32_16x16x32_bf16 v[204:207], a[40:43], a[60:63], v[204:207]
    buffer_load_dwordx4 v11, s[8:11], s38 offen offset:1024 lds
    v_mfma_f32_16x16x32_bf16 v[200:203], a[40:43], a[56:59], v[200:203]
    ds_read_b128 a[16:19], v16 offset:40960
    ds_read_b128 a[20:23], v16 offset:45056
    v_mfma_f32_16x16x32_bf16 v[196:199], a[40:43], a[52:55], v[196:199]
    ds_read_b128 a[24:27], v16 offset:49152
    ds_read_b128 a[28:31], v16 offset:53248
    v_mfma_f32_16x16x32_bf16 v[216:219], a[44:47], a[52:55], v[216:219]
    ds_read_b128 a[32:35], v16 offset:57344
    ds_read_b64_tr_b16 a[4:5], v29 offset:32768
    v_mfma_f32_16x16x32_bf16 v[220:223], a[44:47], a[56:59], v[220:223]
    buffer_load_dwordx4 v12, s[8:11], s38 offen offset:2048 lds
    v_mfma_f32_16x16x32_bf16 v[224:227], a[44:47], a[60:63], v[224:227]
    ds_read_b64_tr_b16 a[6:7], v29 offset:33280
    ds_read_b64_tr_b16 a[8:9], v30 offset:32768
    v_mfma_f32_16x16x32_bf16 v[228:231], a[44:47], a[64:67], v[228:231]
    ds_read_b64_tr_b16 a[10:11], v30 offset:33280
    ds_read_b64_tr_b16 a[12:13], v31 offset:32768
    v_mfma_f32_16x16x32_bf16 v[232:235], a[44:47], a[68:71], v[232:235]
    ds_read_b64_tr_b16 a[14:15], v31 offset:33280
    v_mfma_f32_16x16x32_bf16 v[252:255], a[48:51], a[68:71], v[252:255]
    v_mfma_f32_16x16x32_bf16 v[248:251], a[48:51], a[64:67], v[248:251]
    buffer_load_dwordx4 v13, s[8:11], s38 offen offset:3072 lds
    v_mfma_f32_16x16x32_bf16 v[244:247], a[48:51], a[60:63], v[244:247]
    v_mfma_f32_16x16x32_bf16 v[240:243], a[48:51], a[56:59], v[240:243]
    v_mfma_f32_16x16x32_bf16 v[236:239], a[48:51], a[52:55], v[236:239]
    s_waitcnt lgkmcnt(0)
    s_add_u32 m0, s37, 0x1c000
    v_mfma_f32_16x16x32_bf16 v[176:179], a[0:3], a[16:19], v[176:179]
    s_xor_b32 s38, s32, 0x380000
    v_mfma_f32_16x16x32_bf16 v[180:183], a[0:3], a[20:23], v[180:183]
    v_mfma_f32_16x16x32_bf16 v[184:187], a[0:3], a[24:27], v[184:187]
    buffer_load_dwordx4 v10, s[8:11], s38 offen offset:0 lds
    v_mfma_f32_16x16x32_bf16 v[188:191], a[0:3], a[28:31], v[188:191]
    v_mfma_f32_16x16x32_bf16 v[192:195], a[0:3], a[32:35], v[192:195]
    v_mfma_f32_16x16x32_bf16 v[212:215], a[4:7], a[32:35], v[212:215]
    v_mfma_f32_16x16x32_bf16 v[208:211], a[4:7], a[28:31], v[208:211]
    s_waitcnt vmcnt(14)
    ds_read_b64_tr_b16 a[36:37], v28 offset:49152
    ds_read_b64_tr_b16 a[38:39], v28 offset:49664
    v_mfma_f32_16x16x32_bf16 v[204:207], a[4:7], a[24:27], v[204:207]
    buffer_load_dwordx4 v11, s[8:11], s38 offen offset:1024 lds
    v_mfma_f32_16x16x32_bf16 v[200:203], a[4:7], a[20:23], v[200:203]
    ds_read_b128 a[52:55], v17 offset:40960
    ds_read_b128 a[56:59], v17 offset:45056
    v_mfma_f32_16x16x32_bf16 v[196:199], a[4:7], a[16:19], v[196:199]
    ds_read_b128 a[60:63], v17 offset:49152
    ds_read_b128 a[64:67], v17 offset:53248
    v_mfma_f32_16x16x32_bf16 v[216:219], a[8:11], a[16:19], v[216:219]
    ds_read_b128 a[68:71], v17 offset:57344
    ds_read_b64_tr_b16 a[40:41], v29 offset:49152
    v_mfma_f32_16x16x32_bf16 v[220:223], a[8:11], a[20:23], v[220:223]
    buffer_load_dwordx4 v12, s[8:11], s38 offen offset:2048 lds
    v_mfma_f32_16x16x32_bf16 v[224:227], a[8:11], a[24:27], v[224:227]
    ds_read_b64_tr_b16 a[42:43], v29 offset:49664
    ds_read_b64_tr_b16 a[44:45], v30 offset:49152
    v_mfma_f32_16x16x32_bf16 v[228:231], a[8:11], a[28:31], v[228:231]
    ds_read_b64_tr_b16 a[46:47], v30 offset:49664
    ds_read_b64_tr_b16 a[48:49], v31 offset:49152
    v_mfma_f32_16x16x32_bf16 v[232:235], a[8:11], a[32:35], v[232:235]
    ds_read_b64_tr_b16 a[50:51], v31 offset:49664
    v_mfma_f32_16x16x32_bf16 v[252:255], a[12:15], a[32:35], v[252:255]
    v_mfma_f32_16x16x32_bf16 v[248:251], a[12:15], a[28:31], v[248:251]
    buffer_load_dwordx4 v13, s[8:11], s38 offen offset:3072 lds
    v_mfma_f32_16x16x32_bf16 v[244:247], a[12:15], a[24:27], v[244:247]
    v_mfma_f32_16x16x32_bf16 v[240:243], a[12:15], a[20:23], v[240:243]
    v_mfma_f32_16x16x32_bf16 v[236:239], a[12:15], a[16:19], v[236:239]
    s_waitcnt lgkmcnt(0)
    s_add_u32 m0, s37, 0x20000
    v_mfma_f32_16x16x32_bf16 v[176:179], a[36:39], a[52:55], v[176:179]
    s_xor_b32 s38, s32, 0x3c0000
    v_mfma_f32_16x16x32_bf16 v[180:183], a[36:39], a[56:59], v[180:183]
    v_mfma_f32_16x16x32_bf16 v[184:187], a[36:39], a[60:63], v[184:187]
    buffer_load_dwordx4 v10, s[8:11], s38 offen offset:0 lds
    v_mfma_f32_16x16x32_bf16 v[188:191], a[36:39], a[64:67], v[188:191]
    v_mfma_f32_16x16x32_bf16 v[192:195], a[36:39], a[68:71], v[192:195]
    v_mfma_f32_16x16x32_bf16 v[212:215], a[40:43], a[68:71], v[212:215]
    v_mfma_f32_16x16x32_bf16 v[208:211], a[40:43], a[64:67], v[208:211]
    s_waitcnt vmcnt(9)
    s_barrier
    ds_read_b64_tr_b16 a[0:1], v28 offset:0
    v_mfma_f32_16x16x32_bf16 v[204:207], a[40:43], a[60:63], v[204:207]
    buffer_load_dwordx4 v11, s[8:11], s38 offen offset:1024 lds
    v_mfma_f32_16x16x32_bf16 v[200:203], a[40:43], a[56:59], v[200:203]
    ds_read_b64_tr_b16 a[2:3], v28 offset:512
    ds_read_b128 a[16:19], v14 offset:61440
    v_mfma_f32_16x16x32_bf16 v[196:199], a[40:43], a[52:55], v[196:199]
    v_add_u32 v14, 0x10000, v14
    v_mfma_f32_16x16x32_bf16 v[216:219], a[44:47], a[52:55], v[216:219]
    ds_read_b128 a[20:23], v14 offset:0
    ds_read_b128 a[24:27], v14 offset:4096
    v_mfma_f32_16x16x32_bf16 v[220:223], a[44:47], a[56:59], v[220:223]
    ds_read_b128 a[28:31], v14 offset:8192
    ds_read_b128 a[32:35], v14 offset:12288
    v_mfma_f32_16x16x32_bf16 v[224:227], a[44:47], a[60:63], v[224:227]
    buffer_load_dwordx4 v12, s[8:11], s38 offen offset:2048 lds
    v_mfma_f32_16x16x32_bf16 v[228:231], a[44:47], a[64:67], v[228:231]
    ds_read_b64_tr_b16 a[4:5], v29 offset:0
    ds_read_b64_tr_b16 a[6:7], v29 offset:512
    v_mfma_f32_16x16x32_bf16 v[232:235], a[44:47], a[68:71], v[232:235]
    ds_read_b64_tr_b16 a[8:9], v30 offset:0
    ds_read_b64_tr_b16 a[10:11], v30 offset:512
    v_mfma_f32_16x16x32_bf16 v[252:255], a[48:51], a[68:71], v[252:255]
    ds_read_b64_tr_b16 a[12:13], v31 offset:0
    ds_read_b64_tr_b16 a[14:15], v31 offset:512
    v_mfma_f32_16x16x32_bf16 v[248:251], a[48:51], a[64:67], v[248:251]
    buffer_load_dwordx4 v13, s[8:11], s38 offen offset:3072 lds
    v_mfma_f32_16x16x32_bf16 v[244:247], a[48:51], a[60:63], v[244:247]
    v_mfma_f32_16x16x32_bf16 v[240:243], a[48:51], a[56:59], v[240:243]
    v_mfma_f32_16x16x32_bf16 v[236:239], a[48:51], a[52:55], v[236:239]
    s_waitcnt lgkmcnt(0)
    s_add_u32 m0, s37, 0x24000
    v_mfma_f32_16x16x32_bf16 v[176:179], a[0:3], a[16:19], v[176:179]
    s_mov_b32 s38, 0x0
    v_mfma_f32_16x16x32_bf16 v[180:183], a[0:3], a[20:23], v[180:183]
    v_lshrrev_b32 v1, 4, v0
    v_lshlrev_b32 v1, 1, v1
    v_mfma_f32_16x16x32_bf16 v[184:187], a[0:3], a[24:27], v[184:187]
    buffer_load_dwordx4 v4, s[12:15], s38 offen offset:0 lds
    v_mfma_f32_16x16x32_bf16 v[188:191], a[0:3], a[28:31], v[188:191]
    v_and_b32 v10, 7, v0
    v_xor_b32 v10, v10, v1
    v_mfma_f32_16x16x32_bf16 v[192:195], a[0:3], a[32:35], v[192:195]
    v_lshlrev_b32 v10, 4, v10
    v_lshrrev_b32 v3, 3, v0
    v_mfma_f32_16x16x32_bf16 v[212:215], a[4:7], a[32:35], v[212:215]
    v_lshl_add_u32 v10, v3, 10, v10
    s_lshl_b32 s43, s36, 7
    v_mfma_f32_16x16x32_bf16 v[208:211], a[4:7], a[28:31], v[208:211]
    s_waitcnt vmcnt(9)
    ds_read_b64_tr_b16 a[36:37], v28 offset:16384
    ds_read_b64_tr_b16 a[38:39], v28 offset:16896
    v_mfma_f32_16x16x32_bf16 v[204:207], a[4:7], a[24:27], v[204:207]
    ds_read_b128 a[52:55], v15 offset:61440
    v_add_u32 v15, 0x10000, v15
    v_mfma_f32_16x16x32_bf16 v[200:203], a[4:7], a[20:23], v[200:203]
    buffer_load_dwordx4 v5, s[12:15], s38 offen offset:1024 lds
    v_mfma_f32_16x16x32_bf16 v[196:199], a[4:7], a[16:19], v[196:199]
    ds_read_b128 a[56:59], v15 offset:0
    ds_read_b128 a[60:63], v15 offset:4096
    v_mfma_f32_16x16x32_bf16 v[216:219], a[8:11], a[16:19], v[216:219]
    ds_read_b128 a[64:67], v15 offset:8192
    ds_read_b128 a[68:71], v15 offset:12288
    v_mfma_f32_16x16x32_bf16 v[220:223], a[8:11], a[20:23], v[220:223]
    ds_read_b64_tr_b16 a[40:41], v29 offset:16384
    ds_read_b64_tr_b16 a[42:43], v29 offset:16896
    v_mfma_f32_16x16x32_bf16 v[224:227], a[8:11], a[24:27], v[224:227]
    ds_read_b64_tr_b16 a[44:45], v30 offset:16384
    ds_read_b64_tr_b16 a[46:47], v30 offset:16896
    v_mfma_f32_16x16x32_bf16 v[228:231], a[8:11], a[28:31], v[228:231]
    ds_read_b64_tr_b16 a[48:49], v31 offset:16384
    ds_read_b64_tr_b16 a[50:51], v31 offset:16896
    v_mfma_f32_16x16x32_bf16 v[232:235], a[8:11], a[32:35], v[232:235]
    buffer_load_dwordx4 v6, s[12:15], s38 offen offset:2048 lds
    v_mfma_f32_16x16x32_bf16 v[252:255], a[12:15], a[32:35], v[252:255]
    v_add_u32 v10, s43, v10
    v_add_u32 v11, 0x1c00, v10
    v_mfma_f32_16x16x32_bf16 v[248:251], a[12:15], a[28:31], v[248:251]
    v_add_u32 v12, 0x3800, v10
    v_add_u32 v13, 0x5400, v10
    v_mfma_f32_16x16x32_bf16 v[244:247], a[12:15], a[24:27], v[244:247]
    s_mov_b64 s[8:9], s[70:71]
    s_mov_b32 s10, 32
    s_lshl_b32 s43, s81, 3
    v_mfma_f32_16x16x32_bf16 v[240:243], a[12:15], a[20:23], v[240:243]
    s_and_b32 s44, s2, 7
    s_add_u32 s43, s43, s44
    s_lshl_b32 s43, s43, 2
    v_mfma_f32_16x16x32_bf16 v[236:239], a[12:15], a[16:19], v[236:239]
    s_waitcnt lgkmcnt(0)
    v_lshl_add_u32 v56, v0, 5, s43
    s_lshl_b32 s43, s80, 3
    v_mfma_f32_16x16x32_bf16 v[176:179], a[36:39], a[52:55], v[176:179]
    s_or_b32 s43, s43, s82
    buffer_load_dwordx4 v7, s[12:15], s38 offen offset:3072 lds
    v_mfma_f32_16x16x32_bf16 v[180:183], a[36:39], a[56:59], v[180:183]
    s_or_b32 s43, s43, 16
    v_mov_b32 v57, s43
    v_mfma_f32_16x16x32_bf16 v[184:187], a[36:39], a[60:63], v[184:187]
    v_mfma_f32_16x16x32_bf16 v[188:191], a[36:39], a[64:67], v[188:191]
    s_add_u32 m0, s37, 0x18000
    v_mfma_f32_16x16x32_bf16 v[192:195], a[36:39], a[68:71], v[192:195]
    s_mov_b32 s38, 0x2000
    v_mfma_f32_16x16x32_bf16 v[212:215], a[40:43], a[68:71], v[212:215]
    v_mfma_f32_16x16x32_bf16 v[208:211], a[40:43], a[64:67], v[208:211]
    s_waitcnt vmcnt(8)
    buffer_load_dwordx4 v4, s[12:15], s38 offen offset:0 lds
    v_mfma_f32_16x16x32_bf16 v[204:207], a[40:43], a[60:63], v[204:207]
    ds_read_b64_tr_b16 a[0:1], v28 offset:32768
    ds_read_b64_tr_b16 a[2:3], v28 offset:33280
    v_mfma_f32_16x16x32_bf16 v[200:203], a[40:43], a[56:59], v[200:203]
    ds_read_b128 a[16:19], v16 offset:61440
    v_add_u32 v16, 0x10000, v16
    v_mfma_f32_16x16x32_bf16 v[196:199], a[40:43], a[52:55], v[196:199]
    ds_read_b128 a[20:23], v16 offset:0
    ds_read_b128 a[24:27], v16 offset:4096
    v_mfma_f32_16x16x32_bf16 v[216:219], a[44:47], a[52:55], v[216:219]
    ds_read_b128 a[28:31], v16 offset:8192
    ds_read_b128 a[32:35], v16 offset:12288
    v_mfma_f32_16x16x32_bf16 v[220:223], a[44:47], a[56:59], v[220:223]
    ds_read_b64_tr_b16 a[4:5], v29 offset:32768
    ds_read_b64_tr_b16 a[6:7], v29 offset:33280
    v_mfma_f32_16x16x32_bf16 v[224:227], a[44:47], a[60:63], v[224:227]
    buffer_load_dwordx4 v5, s[12:15], s38 offen offset:1024 lds
    v_mfma_f32_16x16x32_bf16 v[228:231], a[44:47], a[64:67], v[228:231]
    ds_read_b64_tr_b16 a[8:9], v30 offset:32768
    ds_read_b64_tr_b16 a[10:11], v30 offset:33280
    v_mfma_f32_16x16x32_bf16 v[232:235], a[44:47], a[68:71], v[232:235]
    ds_read_b64_tr_b16 a[12:13], v31 offset:32768
    ds_read_b64_tr_b16 a[14:15], v31 offset:33280
    v_mfma_f32_16x16x32_bf16 v[252:255], a[48:51], a[68:71], v[252:255]
    v_mfma_f32_16x16x32_bf16 v[248:251], a[48:51], a[64:67], v[248:251]
    buffer_store_dword v57, v56, s[8:11], 0 offen offset:0 sc1
    v_mfma_f32_16x16x32_bf16 v[244:247], a[48:51], a[60:63], v[244:247]
    v_mfma_f32_16x16x32_bf16 v[240:243], a[48:51], a[56:59], v[240:243]
    buffer_load_dwordx4 v6, s[12:15], s38 offen offset:2048 lds
    v_mfma_f32_16x16x32_bf16 v[236:239], a[48:51], a[52:55], v[236:239]
    s_waitcnt lgkmcnt(0)
    v_mfma_f32_16x16x32_bf16 v[176:179], a[0:3], a[16:19], v[176:179]
    s_and_b32 s43, s36, 1
    s_lshl_b32 s44, s43, 7
    s_xor_b32 s35, s35, s44
    v_mfma_f32_16x16x32_bf16 v[180:183], a[0:3], a[20:23], v[180:183]
    s_lshl_b32 s43, s43, 13
    s_lshl_b32 s45, s36, 7
    v_and_b32 v3, 3, v0
    v_mfma_f32_16x16x32_bf16 v[184:187], a[0:3], a[24:27], v[184:187]
    v_lshl_add_u32 v3, v3, 10, s45
    v_lshrrev_b32 v2, 2, v0
    v_mfma_f32_16x16x32_bf16 v[188:191], a[0:3], a[28:31], v[188:191]
    v_lshl_add_u32 v3, v2, 15, v3
    v_lshrrev_b32 v2, 3, v0
    v_mfma_f32_16x16x32_bf16 v[192:195], a[0:3], a[32:35], v[192:195]
    buffer_load_dwordx4 v7, s[12:15], s38 offen offset:3072 lds
    v_mfma_f32_16x16x32_bf16 v[212:215], a[4:7], a[32:35], v[212:215]
    s_and_b32 s47, s78, 1
    v_lshl_add_u32 v3, v2, 20, v3
    v_mfma_f32_16x16x32_bf16 v[208:211], a[4:7], a[28:31], v[208:211]
    s_waitcnt vmcnt(9)
    ds_read_b64_tr_b16 a[36:37], v28 offset:49152
    ds_read_b64_tr_b16 a[38:39], v28 offset:49664
    v_mfma_f32_16x16x32_bf16 v[204:207], a[4:7], a[24:27], v[204:207]
    ds_read_b128 a[52:55], v17 offset:61440
    v_add_u32 v17, 0x10000, v17
    v_mfma_f32_16x16x32_bf16 v[200:203], a[4:7], a[20:23], v[200:203]
    ds_read_b128 a[56:59], v17 offset:0
    ds_read_b128 a[60:63], v17 offset:4096
    v_mfma_f32_16x16x32_bf16 v[196:199], a[4:7], a[16:19], v[196:199]
    ds_read_b128 a[64:67], v17 offset:8192
    ds_read_b128 a[68:71], v17 offset:12288
    v_mfma_f32_16x16x32_bf16 v[216:219], a[8:11], a[16:19], v[216:219]
    ds_read_b64_tr_b16 a[40:41], v29 offset:49152
    ds_read_b64_tr_b16 a[42:43], v29 offset:49664
    v_mfma_f32_16x16x32_bf16 v[220:223], a[8:11], a[20:23], v[220:223]
    ds_read_b64_tr_b16 a[44:45], v30 offset:49152
    ds_read_b64_tr_b16 a[46:47], v30 offset:49664
    v_mfma_f32_16x16x32_bf16 v[224:227], a[8:11], a[24:27], v[224:227]
    ds_read_b64_tr_b16 a[48:49], v31 offset:49152
    ds_read_b64_tr_b16 a[50:51], v31 offset:49664
    v_mfma_f32_16x16x32_bf16 v[228:231], a[8:11], a[28:31], v[228:231]
    s_cmp_eq_u32 s47, 0
    s_cselect_b64 s[4:5], s[12:13], s[16:17]
    s_cselect_b32 s39, 16384, 0
    v_mfma_f32_16x16x32_bf16 v[232:235], a[8:11], a[32:35], v[232:235]
    s_mov_b32 s6, 0x20000
    v_mfma_f32_16x16x32_bf16 v[252:255], a[12:15], a[32:35], v[252:255]
    v_mfma_f32_16x16x32_bf16 v[248:251], a[12:15], a[28:31], v[248:251]
    v_mfma_f32_16x16x32_bf16 v[244:247], a[12:15], a[24:27], v[244:247]
    s_add_u32 s44, s43, 0x8000
    v_xor_b32 v14, s35, v14
    v_add_u32 v14, s44, v14
    v_mfma_f32_16x16x32_bf16 v[240:243], a[12:15], a[20:23], v[240:243]
    s_add_u32 s44, s43, 0x8000
    v_xor_b32 v15, s35, v15
    v_add_u32 v15, s44, v15
    v_mfma_f32_16x16x32_bf16 v[236:239], a[12:15], a[16:19], v[236:239]
    s_waitcnt lgkmcnt(0)
    s_add_u32 s44, s43, 0x8000
    v_xor_b32 v16, s35, v16
    v_mfma_f32_16x16x32_bf16 v[176:179], a[36:39], a[52:55], v[176:179]
    v_add_u32 v16, s44, v16
    s_add_u32 s44, s43, 0x8000
    v_mfma_f32_16x16x32_bf16 v[180:183], a[36:39], a[56:59], v[180:183]
    v_xor_b32 v17, s35, v17
    v_add_u32 v17, s44, v17
    v_mfma_f32_16x16x32_bf16 v[184:187], a[36:39], a[60:63], v[184:187]
    v_add_u32 v28, 0x4000, v34
    v_xor_b32 v29, 0x20, v28
    v_mfma_f32_16x16x32_bf16 v[188:191], a[36:39], a[64:67], v[188:191]
    v_xor_b32 v30, 0x40, v28
    v_xor_b32 v31, 0x60, v28
    v_mfma_f32_16x16x32_bf16 v[192:195], a[36:39], a[68:71], v[192:195]
    s_xor_b32 s43, s36, 1
    s_mul_i32 s43, s43, 10240
    v_lshl_add_u32 v34, v0, 4, s43
    v_mfma_f32_16x16x32_bf16 v[212:215], a[40:43], a[68:71], v[212:215]
    v_mfma_f32_16x16x32_bf16 v[208:211], a[40:43], a[64:67], v[208:211]
    buffer_load_dword v33, v60, s[4:7], s39 offen offset:0
    v_mfma_f32_16x16x32_bf16 v[204:207], a[40:43], a[60:63], v[204:207]
    s_lshl_b32 s39, s77, 12
    v_mfma_f32_16x16x32_bf16 v[200:203], a[40:43], a[56:59], v[200:203]
    v_mfma_f32_16x16x32_bf16 v[196:199], a[40:43], a[52:55], v[196:199]
    v_mfma_f32_16x16x32_bf16 v[216:219], a[44:47], a[52:55], v[216:219]
    v_mfma_f32_16x16x32_bf16 v[220:223], a[44:47], a[56:59], v[220:223]
    v_mfma_f32_16x16x32_bf16 v[224:227], a[44:47], a[60:63], v[224:227]
    v_mfma_f32_16x16x32_bf16 v[228:231], a[44:47], a[64:67], v[228:231]
    v_mfma_f32_16x16x32_bf16 v[232:235], a[44:47], a[68:71], v[232:235]
    v_mfma_f32_16x16x32_bf16 v[252:255], a[48:51], a[68:71], v[252:255]
    v_mfma_f32_16x16x32_bf16 v[248:251], a[48:51], a[64:67], v[248:251]
    v_mfma_f32_16x16x32_bf16 v[244:247], a[48:51], a[60:63], v[244:247]
    v_mfma_f32_16x16x32_bf16 v[240:243], a[48:51], a[56:59], v[240:243]
    v_mfma_f32_16x16x32_bf16 v[236:239], a[48:51], a[52:55], v[236:239]
    v_pk_mul_f32 v[176:177], v[176:177], s[40:41]
    v_pk_mul_f32 v[178:179], v[178:179], s[40:41]
    v_pk_mul_f32 v[180:181], v[180:181], s[40:41]
    v_pk_mul_f32 v[182:183], v[182:183], s[40:41]
    v_cvt_pk_bf16_f32 v176, v176, v177
    v_cvt_pk_bf16_f32 v177, v178, v179
    v_cvt_pk_bf16_f32 v180, v180, v181
    v_cvt_pk_bf16_f32 v181, v182, v183
    ds_write_b64 v27, v[176:177] offset:0
    ds_write_b64 v27, v[180:181] offset:1024
    v_pk_mul_f32 v[184:185], v[184:185], s[40:41]
    v_pk_mul_f32 v[186:187], v[186:187], s[40:41]
    v_pk_mul_f32 v[188:189], v[188:189], s[40:41]
    v_pk_mul_f32 v[190:191], v[190:191], s[40:41]
    v_cvt_pk_bf16_f32 v184, v184, v185
    v_cvt_pk_bf16_f32 v185, v186, v187
    v_cvt_pk_bf16_f32 v188, v188, v189
    v_cvt_pk_bf16_f32 v189, v190, v191
    ds_write_b64 v27, v[184:185] offset:2048
    ds_write_b64 v27, v[188:189] offset:3072
    v_pk_mul_f32 v[192:193], v[192:193], s[40:41]
    v_pk_mul_f32 v[194:195], v[194:195], s[40:41]
    v_pk_mul_f32 v[212:213], v[212:213], s[40:41]
    v_pk_mul_f32 v[214:215], v[214:215], s[40:41]
    v_cvt_pk_bf16_f32 v192, v192, v193
    v_cvt_pk_bf16_f32 v193, v194, v195
    v_cvt_pk_bf16_f32 v212, v212, v213
    v_cvt_pk_bf16_f32 v213, v214, v215
    ds_write_b64 v27, v[192:193] offset:4096
    ds_write_b64 v27, v[212:213] offset:4608
    v_pk_mul_f32 v[208:209], v[208:209], s[40:41]
    v_pk_mul_f32 v[210:211], v[210:211], s[40:41]
    v_pk_mul_f32 v[204:205], v[204:205], s[40:41]
    v_pk_mul_f32 v[206:207], v[206:207], s[40:41]
    v_cvt_pk_bf16_f32 v208, v208, v209
    v_cvt_pk_bf16_f32 v209, v210, v211
    v_cvt_pk_bf16_f32 v204, v204, v205
    v_cvt_pk_bf16_f32 v205, v206, v207
    ds_write_b64 v27, v[208:209] offset:3584
    ds_write_b64 v27, v[204:205] offset:2560
    v_pk_mul_f32 v[200:201], v[200:201], s[40:41]
    v_pk_mul_f32 v[202:203], v[202:203], s[40:41]
    v_pk_mul_f32 v[196:197], v[196:197], s[40:41]
    v_pk_mul_f32 v[198:199], v[198:199], s[40:41]
    v_cvt_pk_bf16_f32 v200, v200, v201
    v_cvt_pk_bf16_f32 v201, v202, v203
    v_cvt_pk_bf16_f32 v196, v196, v197
    v_cvt_pk_bf16_f32 v197, v198, v199
    ds_write_b64 v27, v[200:201] offset:1536
    ds_write_b64 v27, v[196:197] offset:512
    v_pk_mul_f32 v[216:217], v[216:217], s[40:41]
    v_pk_mul_f32 v[218:219], v[218:219], s[40:41]
    v_pk_mul_f32 v[220:221], v[220:221], s[40:41]
    v_pk_mul_f32 v[222:223], v[222:223], s[40:41]
    v_cvt_pk_bf16_f32 v216, v216, v217
    v_cvt_pk_bf16_f32 v217, v218, v219
    v_cvt_pk_bf16_f32 v220, v220, v221
    v_cvt_pk_bf16_f32 v221, v222, v223
    ds_write_b64 v27, v[216:217] offset:5120
    ds_write_b64 v27, v[220:221] offset:6144
    ds_read_b128 a[80:83], v26 offset:0
    v_pk_mul_f32 v[224:225], v[224:225], s[40:41]
    v_pk_mul_f32 v[226:227], v[226:227], s[40:41]
    v_pk_mul_f32 v[228:229], v[228:229], s[40:41]
    v_pk_mul_f32 v[230:231], v[230:231], s[40:41]
    v_cvt_pk_bf16_f32 v224, v224, v225
    v_cvt_pk_bf16_f32 v225, v226, v227
    v_cvt_pk_bf16_f32 v228, v228, v229
    v_cvt_pk_bf16_f32 v229, v230, v231
    ds_write_b64 v27, v[224:225] offset:7168
    ds_write_b64 v27, v[228:229] offset:8192
    ds_read_b128 a[84:87], v26 offset:1024
    v_pk_mul_f32 v[232:233], v[232:233], s[40:41]
    v_pk_mul_f32 v[234:235], v[234:235], s[40:41]
    v_pk_mul_f32 v[252:253], v[252:253], s[40:41]
    v_pk_mul_f32 v[254:255], v[254:255], s[40:41]
    v_cvt_pk_bf16_f32 v232, v232, v233
    v_cvt_pk_bf16_f32 v233, v234, v235
    v_cvt_pk_bf16_f32 v252, v252, v253
    v_cvt_pk_bf16_f32 v253, v254, v255
    ds_write_b64 v27, v[232:233] offset:9216
    ds_write_b64 v27, v[252:253] offset:9728
    ds_read_b128 a[88:91], v26 offset:2048
    v_pk_mul_f32 v[248:249], v[248:249], s[40:41]
    v_pk_mul_f32 v[250:251], v[250:251], s[40:41]
    v_pk_mul_f32 v[244:245], v[244:245], s[40:41]
    v_pk_mul_f32 v[246:247], v[246:247], s[40:41]
    v_cvt_pk_bf16_f32 v248, v248, v249
    v_cvt_pk_bf16_f32 v249, v250, v251
    v_cvt_pk_bf16_f32 v244, v244, v245
    v_cvt_pk_bf16_f32 v245, v246, v247
    ds_write_b64 v27, v[248:249] offset:8704
    ds_write_b64 v27, v[244:245] offset:7680
    ds_read_b128 a[92:95], v26 offset:3072
    v_pk_mul_f32 v[240:241], v[240:241], s[40:41]
    v_pk_mul_f32 v[242:243], v[242:243], s[40:41]
    v_pk_mul_f32 v[236:237], v[236:237], s[40:41]
    v_pk_mul_f32 v[238:239], v[238:239], s[40:41]
    v_cvt_pk_bf16_f32 v240, v240, v241
    v_cvt_pk_bf16_f32 v241, v242, v243
    v_cvt_pk_bf16_f32 v236, v236, v237
    v_cvt_pk_bf16_f32 v237, v238, v239
    ds_write_b64 v27, v[240:241] offset:6656
    ds_write_b64 v27, v[236:237] offset:5632
    ds_read_b128 a[96:99], v26 offset:4096
    ds_read_b128 a[100:103], v26 offset:5120
    ds_read_b128 a[104:107], v26 offset:6144
    ds_read_b128 a[108:111], v26 offset:7168
    ds_read_b128 a[112:115], v26 offset:8192
    ds_read_b128 a[116:119], v26 offset:9216
    s_add_u32 m0, s37, 0x14000
    s_mov_b32 s38, 0x0
    buffer_load_dwordx4 v8, s[16:19], s38 offen offset:0 lds
    buffer_load_dwordx4 v9, s[16:19], s38 offen offset:1024 lds
    buffer_load_dwordx4 v8, s[16:19], s38 offen offset:2048 lds
    buffer_load_dwordx4 v9, s[16:19], s38 offen offset:3072 lds
    s_waitcnt vmcnt(10) lgkmcnt(6)
    s_barrier
    s_cmp_lg_u32 s79, 0
    s_cbranch_scc1 L_maxpass
L_att:
    ds_read_b128 a[184:187], v14 offset:49152
    ds_read_b128 a[188:191], v15 offset:49152
    ds_read_b128 a[192:195], v16 offset:49152
    ds_read_b128 a[120:123], v34 offset:0
    ds_read_b128 a[196:199], v17 offset:49152
    ds_read_b128 a[140:143], v34 offset:5120
    ds_read_b128 a[124:127], v34 offset:1024
    ds_read_b128 a[144:147], v34 offset:6144
    s_waitcnt lgkmcnt(7)
    v_mfma_f32_16x16x32_bf16 v[56:59], a[184:187], a[80:83], v[36:39]
    s_waitcnt lgkmcnt(6)
    s_add_u32 m0, s37, 0x1c000
    s_mov_b32 s38, 0x4000
    ds_read_b128 a[128:131], v34 offset:2048
    v_mfma_f32_16x16x32_bf16 v[56:59], a[188:191], a[100:103], v[56:59]
    s_waitcnt lgkmcnt(5)
    buffer_load_dwordx4 v4, s[12:15], s38 offen offset:0 lds
    v_mfma_f32_16x16x32_bf16 v[56:59], a[192:195], a[120:123], v[56:59]
    s_waitcnt lgkmcnt(3)
    ds_read_b128 a[148:151], v34 offset:7168
    ds_read_b128 a[132:135], v34 offset:3072
    v_mfma_f32_16x16x32_bf16 v[56:59], a[196:199], a[140:143], v[56:59]
    ds_read_b128 a[152:155], v34 offset:8192
    ds_read_b128 a[136:139], v34 offset:4096
    v_mfma_f32_16x16x32_bf16 v[60:63], a[184:187], a[84:87], v[40:43]
    buffer_load_dwordx4 v5, s[12:15], s38 offen offset:1024 lds
    v_mfma_f32_16x16x32_bf16 v[60:63], a[188:191], a[104:107], v[60:63]
    s_waitcnt lgkmcnt(6)
    ds_read_b128 a[156:159], v34 offset:9216
    ds_read_b128 a[200:203], v14 offset:53248
    v_mfma_f32_16x16x32_bf16 v[60:63], a[192:195], a[124:127], v[60:63]
    s_waitcnt lgkmcnt(7)
    ds_read_b128 a[204:207], v15 offset:53248
    ds_read_b128 a[208:211], v16 offset:53248
    v_mfma_f32_16x16x32_bf16 v[60:63], a[196:199], a[144:147], v[60:63]
    buffer_load_dwordx4 v6, s[12:15], s38 offen offset:2048 lds
    v_mfma_f32_16x16x32_bf16 v[64:67], a[184:187], a[88:91], v[44:47]
    v_exp_f32 v56, v56
    v_mfma_f32_16x16x32_bf16 v[64:67], a[188:191], a[108:111], v[64:67]
    s_waitcnt lgkmcnt(8)
    v_exp_f32 v57, v57
    v_mfma_f32_16x16x32_bf16 v[64:67], a[192:195], a[128:131], v[64:67]
    s_waitcnt lgkmcnt(7)
    buffer_load_dwordx4 v7, s[12:15], s38 offen offset:3072 lds
    v_mfma_f32_16x16x32_bf16 v[64:67], a[196:199], a[148:151], v[64:67]
    s_add_u32 m0, s37, 0xc000
    s_mov_b32 s38, 0x2000
    ds_read_b128 a[212:215], v17 offset:53248
    v_mfma_f32_16x16x32_bf16 v[68:71], a[184:187], a[92:95], v[48:51]
    v_exp_f32 v58, v58
    v_mfma_f32_16x16x32_bf16 v[68:71], a[188:191], a[112:115], v[68:71]
    s_waitcnt lgkmcnt(7)
    buffer_load_dwordx4 v8, s[16:19], s38 offen offset:0 lds
    v_mfma_f32_16x16x32_bf16 v[68:71], a[192:195], a[132:135], v[68:71]
    s_waitcnt lgkmcnt(6)
    v_exp_f32 v59, v59
    v_mfma_f32_16x16x32_bf16 v[68:71], a[196:199], a[152:155], v[68:71]
    v_exp_f32 v60, v60
    v_mfma_f32_16x16x32_bf16 v[72:75], a[184:187], a[96:99], v[52:55]
    v_exp_f32 v61, v61
    v_mfma_f32_16x16x32_bf16 v[72:75], a[188:191], a[116:119], v[72:75]
    s_waitcnt lgkmcnt(5)
    v_exp_f32 v62, v62
    v_mfma_f32_16x16x32_bf16 v[72:75], a[192:195], a[136:139], v[72:75]
    s_waitcnt lgkmcnt(4)
    v_exp_f32 v63, v63
    v_mfma_f32_16x16x32_bf16 v[72:75], a[196:199], a[156:159], v[72:75]
    s_waitcnt lgkmcnt(0)
    v_exp_f32 v64, v64
    v_mfma_f32_16x16x32_bf16 v[96:99], a[200:203], a[80:83], v[36:39]
    v_exp_f32 v65, v65
    v_mfma_f32_16x16x32_bf16 v[96:99], a[204:207], a[100:103], v[96:99]
    v_exp_f32 v66, v66
    v_mfma_f32_16x16x32_bf16 v[96:99], a[208:211], a[120:123], v[96:99]
    v_exp_f32 v67, v67
    v_mfma_f32_16x16x32_bf16 v[96:99], a[212:215], a[140:143], v[96:99]
    s_waitcnt vmcnt(10) lgkmcnt(0)
    s_barrier
    v_mfma_f32_16x16x32_bf16 v[100:103], a[200:203], a[84:87], v[40:43]
    buffer_load_dwordx4 v9, s[16:19], s38 offen offset:1024 lds
    v_mfma_f32_16x16x32_bf16 v[100:103], a[204:207], a[104:107], v[100:103]
    ds_read_b128 a[216:219], v14 offset:0
    ds_read_b128 a[184:187], v15 offset:0
    v_mfma_f32_16x16x32_bf16 v[100:103], a[208:211], a[124:127], v[100:103]
    ds_read_b128 a[188:191], v16 offset:0
    ds_read_b128 a[192:195], v17 offset:0
    v_mfma_f32_16x16x32_bf16 v[100:103], a[212:215], a[144:147], v[100:103]
    v_exp_f32 v68, v68
    v_mfma_f32_16x16x32_bf16 v[104:107], a[200:203], a[88:91], v[44:47]
    v_exp_f32 v69, v69
    v_mfma_f32_16x16x32_bf16 v[104:107], a[204:207], a[108:111], v[104:107]
L_hop1:
    s_cbranch_execz L_hop_ret
    v_exp_f32 v70, v70
    v_mfma_f32_16x16x32_bf16 v[104:107], a[208:211], a[128:131], v[104:107]
    v_exp_f32 v71, v71
    v_mfma_f32_16x16x32_bf16 v[104:107], a[212:215], a[148:151], v[104:107]
    v_exp_f32 v72, v72
    v_mfma_f32_16x16x32_bf16 v[108:111], a[200:203], a[92:95], v[48:51]
    v_exp_f32 v73, v73
    v_mfma_f32_16x16x32_bf16 v[108:111], a[204:207], a[112:115], v[108:111]
    buffer_load_dwordx4 v8, s[16:19], s38 offen offset:2048 lds
    v_mfma_f32_16x16x32_bf16 v[108:111], a[208:211], a[132:135], v[108:111]
    v_exp_f32 v74, v74
    v_mfma_f32_16x16x32_bf16 v[108:111], a[212:215], a[152:155], v[108:111]
    v_cvt_pk_bf16_f32 v56, v56, v57
    v_cvt_pk_bf16_f32 v57, v58, v59
    v_mfma_f32_16x16x32_bf16 v[112:115], a[200:203], a[96:99], v[52:55]
    v_exp_f32 v75, v75
    v_mfma_f32_16x16x32_bf16 v[112:115], a[204:207], a[116:119], v[112:115]
    v_cvt_pk_bf16_f32 v60, v60, v61
    v_cvt_pk_bf16_f32 v61, v62, v63
    v_mfma_f32_16x16x32_bf16 v[112:115], a[208:211], a[136:139], v[112:115]
    v_exp_f32 v96, v96
    v_mfma_f32_16x16x32_bf16 v[112:115], a[212:215], a[156:159], v[112:115]
    s_waitcnt lgkmcnt(0)
    v_cvt_pk_bf16_f32 v64, v64, v65
    v_cvt_pk_bf16_f32 v65, v66, v67
    v_mfma_f32_16x16x32_bf16 v[76:79], a[216:219], a[80:83], v[36:39]
    v_exp_f32 v97, v97
    v_mfma_f32_16x16x32_bf16 v[76:79], a[184:187], a[100:103], v[76:79]
    v_cvt_pk_bf16_f32 v68, v68, v69
    v_cvt_pk_bf16_f32 v69, v70, v71
    v_mfma_f32_16x16x32_bf16 v[76:79], a[188:191], a[120:123], v[76:79]
    v_exp_f32 v98, v98
    v_mfma_f32_16x16x32_bf16 v[76:79], a[192:195], a[140:143], v[76:79]
    buffer_load_dwordx4 v9, s[16:19], s38 offen offset:3072 lds
    v_mfma_f32_16x16x32_bf16 v[80:83], a[216:219], a[84:87], v[40:43]
    ds_read_b128 a[196:199], v14 offset:4096
    ds_read_b128 a[200:203], v15 offset:4096
    v_mfma_f32_16x16x32_bf16 v[80:83], a[184:187], a[104:107], v[80:83]
    ds_read_b128 a[204:207], v16 offset:4096
    ds_read_b128 a[208:211], v17 offset:4096
    v_mfma_f32_16x16x32_bf16 v[80:83], a[188:191], a[124:127], v[80:83]
    v_cvt_pk_bf16_f32 v72, v72, v73
    v_cvt_pk_bf16_f32 v73, v74, v75
    v_mfma_f32_16x16x32_bf16 v[80:83], a[192:195], a[144:147], v[80:83]
    v_exp_f32 v99, v99
    v_mfma_f32_16x16x32_bf16 v[84:87], a[216:219], a[88:91], v[44:47]
    v_cvt_pk_bf16_f32 v58, v96, v97
    v_cvt_pk_bf16_f32 v59, v98, v99
    v_mfma_f32_16x16x32_bf16 v[84:87], a[184:187], a[108:111], v[84:87]
    v_exp_f32 v100, v100
    v_mfma_f32_16x16x32_bf16 v[84:87], a[188:191], a[128:131], v[84:87]
    s_add_u32 m0, s37, 0x24000
    v_exp_f32 v101, v101
    v_mfma_f32_16x16x32_bf16 v[84:87], a[192:195], a[148:151], v[84:87]
    s_mov_b32 s38, 0x6000
    v_exp_f32 v102, v102
    v_mfma_f32_16x16x32_bf16 v[88:91], a[216:219], a[92:95], v[48:51]
    v_exp_f32 v103, v103
    v_mfma_f32_16x16x32_bf16 v[88:91], a[184:187], a[112:115], v[88:91]
    buffer_load_dwordx4 v4, s[12:15], s38 offen offset:0 lds
    v_mfma_f32_16x16x32_bf16 v[88:91], a[188:191], a[132:135], v[88:91]
    v_cvt_pk_bf16_f32 v62, v100, v101
    v_cvt_pk_bf16_f32 v63, v102, v103
    v_mfma_f32_16x16x32_bf16 v[88:91], a[192:195], a[152:155], v[88:91]
    v_exp_f32 v104, v104
    v_mfma_f32_16x16x32_bf16 v[92:95], a[216:219], a[96:99], v[52:55]
    v_exp_f32 v105, v105
    v_mfma_f32_16x16x32_bf16 v[92:95], a[184:187], a[116:119], v[92:95]
    v_exp_f32 v106, v106
    v_mfma_f32_16x16x32_bf16 v[92:95], a[188:191], a[136:139], v[92:95]
    v_exp_f32 v107, v107
    v_mfma_f32_16x16x32_bf16 v[92:95], a[192:195], a[156:159], v[92:95]
    s_waitcnt lgkmcnt(0)
    v_cvt_pk_bf16_f32 v66, v104, v105
    v_cvt_pk_bf16_f32 v67, v106, v107
    v_mfma_f32_16x16x32_bf16 v[96:99], a[196:199], a[80:83], v[36:39]
    v_exp_f32 v108, v108
    v_mfma_f32_16x16x32_bf16 v[96:99], a[200:203], a[100:103], v[96:99]
    v_exp_f32 v109, v109
    v_mfma_f32_16x16x32_bf16 v[96:99], a[204:207], a[120:123], v[96:99]
    v_exp_f32 v110, v110
    v_mfma_f32_16x16x32_bf16 v[96:99], a[208:211], a[140:143], v[96:99]
    buffer_load_dwordx4 v5, s[12:15], s38 offen offset:1024 lds
    v_mfma_f32_16x16x32_bf16 v[100:103], a[196:199], a[84:87], v[40:43]
    v_exp_f32 v111, v111
    v_mfma_f32_16x16x32_bf16 v[100:103], a[200:203], a[104:107], v[100:103]
    v_cvt_pk_bf16_f32 v70, v108, v109
    v_cvt_pk_bf16_f32 v71, v110, v111
    v_mfma_f32_16x16x32_bf16 v[100:103], a[204:207], a[124:127], v[100:103]
    v_exp_f32 v112, v112
    v_mfma_f32_16x16x32_bf16 v[100:103], a[208:211], a[144:147], v[100:103]
    v_exp_f32 v113, v113
    v_mfma_f32_16x16x32_bf16 v[104:107], a[196:199], a[88:91], v[44:47]
    v_exp_f32 v114, v114
    v_mfma_f32_16x16x32_bf16 v[104:107], a[200:203], a[108:111], v[104:107]
    v_exp_f32 v115, v115
    v_mfma_f32_16x16x32_bf16 v[104:107], a[204:207], a[128:131], v[104:107]
    v_cvt_pk_bf16_f32 v74, v112, v113
    v_cvt_pk_bf16_f32 v75, v114, v115
    v_mfma_f32_16x16x32_bf16 v[104:107], a[208:211], a[148:151], v[104:107]
    v_exp_f32 v76, v76
    v_mfma_f32_16x16x32_bf16 v[108:111], a[196:199], a[92:95], v[48:51]
    v_exp_f32 v77, v77
    v_mfma_f32_16x16x32_bf16 v[108:111], a[200:203], a[112:115], v[108:111]
    s_waitcnt vmcnt(6) lgkmcnt(0)
    s_barrier
    v_mfma_f32_16x16x32_bf16 v[108:111], a[204:207], a[132:135], v[108:111]
    s_mul_i32 s43, s36, 5120
    buffer_load_dwordx4 v6, s[12:15], s38 offen offset:2048 lds
    v_mfma_f32_16x16x32_bf16 v[108:111], a[208:211], a[152:155], v[108:111]
    ds_read_b64_tr_b16 a[212:213], v18 offset:49152
    ds_read_b64_tr_b16 a[214:215], v18 offset:53248
    v_mfma_f32_16x16x32_bf16 v[112:115], a[196:199], a[96:99], v[52:55]
    v_exp_f32 v78, v78
    v_mfma_f32_16x16x32_bf16 v[112:115], a[200:203], a[116:119], v[112:115]
    v_exp_f32 v79, v79
    v_mfma_f32_16x16x32_bf16 v[112:115], a[204:207], a[136:139], v[112:115]
    ds_read_b64_tr_b16 a[216:217], v19 offset:49152
    ds_read_b64_tr_b16 a[218:219], v19 offset:53248
    v_mfma_f32_16x16x32_bf16 v[112:115], a[208:211], a[156:159], v[112:115]
    v_exp_f32 v80, v80
    v_mfma_f32_16x16x32_bf16 a[160:163], a[180:183], v[56:59], 0
    v_exp_f32 v81, v81
    v_mfma_f32_16x16x32_bf16 a[164:167], a[180:183], v[60:63], 0
    v_exp_f32 v82, v82
    v_mfma_f32_16x16x32_bf16 a[168:171], a[180:183], v[64:67], 0
    v_exp_f32 v83, v83
    v_mfma_f32_16x16x32_bf16 a[172:175], a[180:183], v[68:71], 0
    buffer_load_dwordx4 v7, s[12:15], s38 offen offset:3072 lds
    v_mfma_f32_16x16x32_bf16 a[176:179], a[180:183], v[72:75], 0
    s_waitcnt lgkmcnt(2)
    ds_read_b64_tr_b16 a[184:185], v20 offset:49152
    ds_read_b64_tr_b16 a[186:187], v20 offset:53248
    v_mfma_f32_16x16x32_bf16 v[132:135], a[212:215], v[72:75], 0
    v_exp_f32 v84, v84
    v_mfma_f32_16x16x32_bf16 v[128:131], a[212:215], v[68:71], 0
    v_exp_f32 v85, v85
    v_mfma_f32_16x16x32_bf16 v[124:127], a[212:215], v[64:67], 0
    v_exp_f32 v86, v86
    v_mfma_f32_16x16x32_bf16 v[120:123], a[212:215], v[60:63], 0
    ds_read_b64_tr_b16 a[188:189], v21 offset:49152
    ds_read_b64_tr_b16 a[190:191], v21 offset:53248
    v_mfma_f32_16x16x32_bf16 v[116:119], a[212:215], v[56:59], 0
    s_waitcnt lgkmcnt(4)
    v_exp_f32 v87, v87
    v_mfma_f32_16x16x32_bf16 v[136:139], a[216:219], v[56:59], 0
    s_add_u32 m0, s37, 0x10000
    v_exp_f32 v88, v88
    v_mfma_f32_16x16x32_bf16 v[140:143], a[216:219], v[60:63], 0
    s_mov_b32 s38, 0x4000
    v_exp_f32 v89, v89
    v_mfma_f32_16x16x32_bf16 v[144:147], a[216:219], v[64:67], 0
    v_exp_f32 v90, v90
    v_mfma_f32_16x16x32_bf16 v[148:151], a[216:219], v[68:71], 0
    buffer_load_dwordx4 v8, s[16:19], s38 offen offset:0 lds
    v_mfma_f32_16x16x32_bf16 v[152:155], a[216:219], v[72:75], 0
    s_waitcnt lgkmcnt(2)
    ds_read_b64_tr_b16 a[192:193], v22 offset:49152
    ds_read_b64_tr_b16 a[194:195], v22 offset:53248
    v_mfma_f32_16x16x32_bf16 v[172:175], a[184:187], v[72:75], 0
    v_exp_f32 v91, v91
    v_mfma_f32_16x16x32_bf16 v[168:171], a[184:187], v[68:71], 0
    v_exp_f32 v92, v92
    v_mfma_f32_16x16x32_bf16 v[164:167], a[184:187], v[64:67], 0
    v_exp_f32 v93, v93
    v_mfma_f32_16x16x32_bf16 v[160:163], a[184:187], v[60:63], 0
    ds_read_b64_tr_b16 a[196:197], v23 offset:49152
    ds_read_b64_tr_b16 a[198:199], v23 offset:53248
    v_mfma_f32_16x16x32_bf16 v[156:159], a[184:187], v[56:59], 0
    s_waitcnt lgkmcnt(4)
    v_exp_f32 v94, v94
    v_mfma_f32_16x16x32_bf16 a[220:223], a[188:191], v[56:59], 0
    v_cvt_pk_bf16_f32 v76, v76, v77
    v_cvt_pk_bf16_f32 v77, v78, v79
    v_mfma_f32_16x16x32_bf16 a[224:227], a[188:191], v[60:63], 0
    v_exp_f32 v95, v95
    v_mfma_f32_16x16x32_bf16 a[228:231], a[188:191], v[64:67], 0
    v_cvt_pk_bf16_f32 v80, v80, v81
    v_cvt_pk_bf16_f32 v81, v82, v83
    v_mfma_f32_16x16x32_bf16 a[232:235], a[188:191], v[68:71], 0
    buffer_load_dwordx4 v9, s[16:19], s38 offen offset:1024 lds
    v_mfma_f32_16x16x32_bf16 a[236:239], a[188:191], v[72:75], 0
    s_waitcnt lgkmcnt(2)
    ds_read_b64_tr_b16 a[200:201], v24 offset:49152
    ds_read_b64_tr_b16 a[202:203], v24 offset:53248
    v_mfma_f32_16x16x32_bf16 v[192:195], a[192:195], v[72:75], 0
    v_exp_f32 v96, v96
    v_mfma_f32_16x16x32_bf16 v[188:191], a[192:195], v[68:71], 0
    v_cvt_pk_bf16_f32 v84, v84, v85
    v_cvt_pk_bf16_f32 v85, v86, v87
    v_mfma_f32_16x16x32_bf16 v[184:187], a[192:195], v[64:67], 0
    v_exp_f32 v97, v97
    v_mfma_f32_16x16x32_bf16 v[180:183], a[192:195], v[60:63], 0
    ds_read_b64_tr_b16 a[204:205], v25 offset:49152
    ds_read_b64_tr_b16 a[206:207], v25 offset:53248
    v_mfma_f32_16x16x32_bf16 v[176:179], a[192:195], v[56:59], 0
    s_waitcnt lgkmcnt(4)
    ds_read_b128 a[208:211], v14 offset:16384
    ds_read_b128 a[212:215], v15 offset:16384
    v_mfma_f32_16x16x32_bf16 v[196:199], a[196:199], v[56:59], 0
    ds_read_b128 a[216:219], v16 offset:16384
    ds_read_b128 a[184:187], v17 offset:16384
    v_mfma_f32_16x16x32_bf16 v[200:203], a[196:199], v[60:63], 0
    v_cvt_pk_bf16_f32 v88, v88, v89
    v_cvt_pk_bf16_f32 v89, v90, v91
    v_mfma_f32_16x16x32_bf16 v[204:207], a[196:199], v[64:67], 0
    v_exp_f32 v98, v98
    v_mfma_f32_16x16x32_bf16 v[208:211], a[196:199], v[68:71], 0
    buffer_load_dwordx4 v8, s[16:19], s38 offen offset:2048 lds
    v_mfma_f32_16x16x32_bf16 v[212:215], a[196:199], v[72:75], 0
    s_waitcnt lgkmcnt(6)
    v_cvt_pk_bf16_f32 v92, v92, v93
    v_cvt_pk_bf16_f32 v93, v94, v95
    v_mfma_f32_16x16x32_bf16 v[232:235], a[200:203], v[72:75], 0
    v_exp_f32 v99, v99
    v_mfma_f32_16x16x32_bf16 v[228:231], a[200:203], v[68:71], 0
    v_cvt_pk_bf16_f32 v78, v96, v97
    v_cvt_pk_bf16_f32 v79, v98, v99
    v_mfma_f32_16x16x32_bf16 v[224:227], a[200:203], v[64:67], 0
    v_exp_f32 v100, v100
    v_mfma_f32_16x16x32_bf16 v[220:223], a[200:203], v[60:63], 0
    v_exp_f32 v101, v101
    v_mfma_f32_16x16x32_bf16 v[216:219], a[200:203], v[56:59], 0
    s_waitcnt lgkmcnt(4)
    v_exp_f32 v102, v102
    v_mfma_f32_16x16x32_bf16 v[236:239], a[204:207], v[56:59], 0
    v_exp_f32 v103, v103
    v_mfma_f32_16x16x32_bf16 v[240:243], a[204:207], v[60:63], 0
    v_cvt_pk_bf16_f32 v82, v100, v101
    v_cvt_pk_bf16_f32 v83, v102, v103
    v_mfma_f32_16x16x32_bf16 v[244:247], a[204:207], v[64:67], 0
    v_exp_f32 v104, v104
    v_mfma_f32_16x16x32_bf16 v[248:251], a[204:207], v[68:71], 0
    buffer_load_dwordx4 v9, s[16:19], s38 offen offset:3072 lds
    v_mfma_f32_16x16x32_bf16 v[252:255], a[204:207], v[72:75], 0
    s_waitcnt lgkmcnt(0)
    v_exp_f32 v105, v105
    v_mfma_f32_16x16x32_bf16 v[56:59], a[208:211], a[80:83], v[36:39]
    v_exp_f32 v106, v106
    v_mfma_f32_16x16x32_bf16 v[56:59], a[212:215], a[100:103], v[56:59]
    v_exp_f32 v107, v107
    v_mfma_f32_16x16x32_bf16 v[56:59], a[216:219], a[120:123], v[56:59]
    v_cvt_pk_bf16_f32 v86, v104, v105
    v_cvt_pk_bf16_f32 v87, v106, v107
    v_mfma_f32_16x16x32_bf16 v[56:59], a[184:187], a[140:143], v[56:59]
    v_exp_f32 v108, v108
    v_mfma_f32_16x16x32_bf16 v[60:63], a[208:211], a[84:87], v[40:43]
    ds_read_b128 a[188:191], v14 offset:20480
    ds_read_b128 a[192:195], v15 offset:20480
    v_mfma_f32_16x16x32_bf16 v[60:63], a[212:215], a[104:107], v[60:63]
    s_add_u32 m0, s37, 0x18000
    ds_read_b128 a[196:199], v16 offset:20480
    ds_read_b128 a[200:203], v17 offset:20480
    v_mfma_f32_16x16x32_bf16 v[60:63], a[216:219], a[124:127], v[60:63]
    s_mov_b32 s38, 0x8000
    v_exp_f32 v109, v109
    v_mfma_f32_16x16x32_bf16 v[60:63], a[184:187], a[144:147], v[60:63]
    v_exp_f32 v110, v110
    v_mfma_f32_16x16x32_bf16 v[64:67], a[208:211], a[88:91], v[44:47]
    buffer_load_dwordx4 v4, s[12:15], s38 offen offset:0 lds
    v_mfma_f32_16x16x32_bf16 v[64:67], a[212:215], a[108:111], v[64:67]
    v_exp_f32 v111, v111
    v_mfma_f32_16x16x32_bf16 v[64:67], a[216:219], a[128:131], v[64:67]
    v_cvt_pk_bf16_f32 v90, v108, v109
    v_cvt_pk_bf16_f32 v91, v110, v111
    v_mfma_f32_16x16x32_bf16 v[64:67], a[184:187], a[148:151], v[64:67]
    v_exp_f32 v112, v112
    v_mfma_f32_16x16x32_bf16 v[68:71], a[208:211], a[92:95], v[48:51]
    v_exp_f32 v113, v113
    v_mfma_f32_16x16x32_bf16 v[68:71], a[212:215], a[112:115], v[68:71]
    v_exp_f32 v114, v114
    v_mfma_f32_16x16x32_bf16 v[68:71], a[216:219], a[132:135], v[68:71]
    v_exp_f32 v115, v115
    v_mfma_f32_16x16x32_bf16 v[68:71], a[184:187], a[152:155], v[68:71]
    v_cvt_pk_bf16_f32 v94, v112, v113
    v_cvt_pk_bf16_f32 v95, v114, v115
    v_mfma_f32_16x16x32_bf16 v[72:75], a[208:211], a[96:99], v[52:55]
    v_exp_f32 v56, v56
    v_mfma_f32_16x16x32_bf16 v[72:75], a[212:215], a[116:119], v[72:75]
    v_exp_f32 v57, v57
    v_mfma_f32_16x16x32_bf16 v[72:75], a[216:219], a[136:139], v[72:75]
    buffer_load_dwordx4 v5, s[12:15], s38 offen offset:1024 lds
    v_mfma_f32_16x16x32_bf16 v[72:75], a[184:187], a[156:159], v[72:75]
    s_waitcnt lgkmcnt(0)
    v_exp_f32 v58, v58
    v_mfma_f32_16x16x32_bf16 v[96:99], a[188:191], a[80:83], v[36:39]
    v_exp_f32 v59, v59
    v_mfma_f32_16x16x32_bf16 v[96:99], a[192:195], a[100:103], v[96:99]
    v_exp_f32 v60, v60
    v_mfma_f32_16x16x32_bf16 v[96:99], a[196:199], a[120:123], v[96:99]
    v_exp_f32 v61, v61
    v_mfma_f32_16x16x32_bf16 v[96:99], a[200:203], a[140:143], v[96:99]
    v_exp_f32 v62, v62
    v_mfma_f32_16x16x32_bf16 v[100:103], a[188:191], a[84:87], v[40:43]
    v_exp_f32 v63, v63
    v_mfma_f32_16x16x32_bf16 v[100:103], a[192:195], a[104:107], v[100:103]
    v_exp_f32 v64, v64
    v_mfma_f32_16x16x32_bf16 v[100:103], a[196:199], a[124:127], v[100:103]
    v_exp_f32 v65, v65
    v_mfma_f32_16x16x32_bf16 v[100:103], a[200:203], a[144:147], v[100:103]
    v_exp_f32 v66, v66
    v_mfma_f32_16x16x32_bf16 v[104:107], a[188:191], a[88:91], v[44:47]
    buffer_load_dwordx4 v6, s[12:15], s38 offen offset:2048 lds
    v_mfma_f32_16x16x32_bf16 v[104:107], a[192:195], a[108:111], v[104:107]
    v_exp_f32 v67, v67
    v_mfma_f32_16x16x32_bf16 v[104:107], a[196:199], a[128:131], v[104:107]
    v_exp_f32 v68, v68
    v_mfma_f32_16x16x32_bf16 v[104:107], a[200:203], a[148:151], v[104:107]
    v_exp_f32 v69, v69
    v_mfma_f32_16x16x32_bf16 v[108:111], a[188:191], a[92:95], v[48:51]
    v_exp_f32 v70, v70
    v_mfma_f32_16x16x32_bf16 v[108:111], a[192:195], a[112:115], v[108:111]
    s_waitcnt vmcnt(7) lgkmcnt(0)
    s_barrier
    v_mfma_f32_16x16x32_bf16 v[108:111], a[196:199], a[132:135], v[108:111]
    ds_read_b64_tr_b16 a[204:205], v18 offset:16384
    ds_read_b64_tr_b16 a[206:207], v18 offset:20480
    v_mfma_f32_16x16x32_bf16 v[108:111], a[200:203], a[152:155], v[108:111]
    v_exp_f32 v71, v71
    v_mfma_f32_16x16x32_bf16 v[112:115], a[188:191], a[96:99], v[52:55]
    v_exp_f32 v72, v72
    v_mfma_f32_16x16x32_bf16 v[112:115], a[192:195], a[116:119], v[112:115]
    v_exp_f32 v73, v73
    v_mfma_f32_16x16x32_bf16 v[112:115], a[196:199], a[136:139], v[112:115]
    buffer_load_dwordx4 v7, s[12:15], s38 offen offset:3072 lds
    v_mfma_f32_16x16x32_bf16 v[112:115], a[200:203], a[156:159], v[112:115]
    ds_read_b64_tr_b16 a[208:209], v19 offset:16384
    ds_read_b64_tr_b16 a[210:211], v19 offset:20480
    v_mfma_f32_16x16x32_bf16 a[160:163], a[180:183], v[76:79], a[160:163]
    v_exp_f32 v74, v74
    v_mfma_f32_16x16x32_bf16 a[164:167], a[180:183], v[80:83], a[164:167]
    v_cvt_pk_bf16_f32 v56, v56, v57
    v_cvt_pk_bf16_f32 v57, v58, v59
    v_mfma_f32_16x16x32_bf16 a[168:171], a[180:183], v[84:87], a[168:171]
    v_exp_f32 v75, v75
    v_mfma_f32_16x16x32_bf16 a[172:175], a[180:183], v[88:91], a[172:175]
    ds_read_b64_tr_b16 a[212:213], v20 offset:16384
    ds_read_b64_tr_b16 a[214:215], v20 offset:20480
    v_mfma_f32_16x16x32_bf16 a[176:179], a[180:183], v[92:95], a[176:179]
    s_waitcnt lgkmcnt(4)
    v_cvt_pk_bf16_f32 v60, v60, v61
    v_cvt_pk_bf16_f32 v61, v62, v63
    v_mfma_f32_16x16x32_bf16 v[132:135], a[204:207], v[92:95], v[132:135]
    s_add_u32 m0, s37, 0x8000
    v_exp_f32 v96, v96
    v_mfma_f32_16x16x32_bf16 v[128:131], a[204:207], v[88:91], v[128:131]
    s_mov_b32 s38, 0x6000
    v_cvt_pk_bf16_f32 v64, v64, v65
    v_cvt_pk_bf16_f32 v65, v66, v67
    v_mfma_f32_16x16x32_bf16 v[124:127], a[204:207], v[84:87], v[124:127]
    v_exp_f32 v97, v97
    v_mfma_f32_16x16x32_bf16 v[120:123], a[204:207], v[80:83], v[120:123]
    buffer_load_dwordx4 v8, s[16:19], s38 offen offset:0 lds
    v_mfma_f32_16x16x32_bf16 v[116:119], a[204:207], v[76:79], v[116:119]
    s_waitcnt lgkmcnt(2)
    ds_read_b64_tr_b16 a[216:217], v21 offset:16384
    ds_read_b64_tr_b16 a[218:219], v21 offset:20480
    v_mfma_f32_16x16x32_bf16 v[136:139], a[208:211], v[76:79], v[136:139]
    v_cvt_pk_bf16_f32 v68, v68, v69
    v_cvt_pk_bf16_f32 v69, v70, v71
    v_mfma_f32_16x16x32_bf16 v[140:143], a[208:211], v[80:83], v[140:143]
    v_exp_f32 v98, v98
    v_mfma_f32_16x16x32_bf16 v[144:147], a[208:211], v[84:87], v[144:147]
    v_cvt_pk_bf16_f32 v72, v72, v73
    v_cvt_pk_bf16_f32 v73, v74, v75
    v_mfma_f32_16x16x32_bf16 v[148:151], a[208:211], v[88:91], v[148:151]
    ds_read_b64_tr_b16 a[184:185], v22 offset:16384
    ds_read_b64_tr_b16 a[186:187], v22 offset:20480
    v_mfma_f32_16x16x32_bf16 v[152:155], a[208:211], v[92:95], v[152:155]
    s_waitcnt lgkmcnt(4)
    v_exp_f32 v99, v99
    v_mfma_f32_16x16x32_bf16 v[172:175], a[212:215], v[92:95], v[172:175]
    v_cvt_pk_bf16_f32 v58, v96, v97
    v_cvt_pk_bf16_f32 v59, v98, v99
    v_mfma_f32_16x16x32_bf16 v[168:171], a[212:215], v[88:91], v[168:171]
    v_exp_f32 v100, v100
    v_mfma_f32_16x16x32_bf16 v[164:167], a[212:215], v[84:87], v[164:167]
    v_exp_f32 v101, v101
    v_mfma_f32_16x16x32_bf16 v[160:163], a[212:215], v[80:83], v[160:163]
    buffer_load_dwordx4 v9, s[16:19], s38 offen offset:1024 lds
    v_mfma_f32_16x16x32_bf16 v[156:159], a[212:215], v[76:79], v[156:159]
    s_waitcnt lgkmcnt(2)
    ds_read_b64_tr_b16 a[188:189], v23 offset:16384
    ds_read_b64_tr_b16 a[190:191], v23 offset:20480
    v_mfma_f32_16x16x32_bf16 a[220:223], a[216:219], v[76:79], a[220:223]
    v_exp_f32 v102, v102
    v_mfma_f32_16x16x32_bf16 a[224:227], a[216:219], v[80:83], a[224:227]
    v_exp_f32 v103, v103
    v_mfma_f32_16x16x32_bf16 a[228:231], a[216:219], v[84:87], a[228:231]
    v_cvt_pk_bf16_f32 v62, v100, v101
    v_cvt_pk_bf16_f32 v63, v102, v103
    v_mfma_f32_16x16x32_bf16 a[232:235], a[216:219], v[88:91], a[232:235]
    ds_read_b64_tr_b16 a[192:193], v24 offset:16384
    ds_read_b64_tr_b16 a[194:195], v24 offset:20480
    v_mfma_f32_16x16x32_bf16 a[236:239], a[216:219], v[92:95], a[236:239]
    s_waitcnt lgkmcnt(4)
    v_exp_f32 v104, v104
    v_mfma_f32_16x16x32_bf16 v[192:195], a[184:187], v[92:95], v[192:195]
    v_exp_f32 v105, v105
    v_mfma_f32_16x16x32_bf16 v[188:191], a[184:187], v[88:91], v[188:191]
    v_exp_f32 v106, v106
    v_mfma_f32_16x16x32_bf16 v[184:187], a[184:187], v[84:87], v[184:187]
    buffer_load_dwordx4 v8, s[16:19], s38 offen offset:2048 lds
    v_mfma_f32_16x16x32_bf16 v[180:183], a[184:187], v[80:83], v[180:183]
    ds_read_b64_tr_b16 a[196:197], v25 offset:16384
    ds_read_b64_tr_b16 a[198:199], v25 offset:20480
    v_mfma_f32_16x16x32_bf16 v[176:179], a[184:187], v[76:79], v[176:179]
    s_waitcnt lgkmcnt(4)
    ds_read_b128 a[200:203], v14 offset:49152
    ds_read_b128 a[204:207], v15 offset:49152
    v_mfma_f32_16x16x32_bf16 v[196:199], a[188:191], v[76:79], v[196:199]
    ds_read_b128 a[208:211], v16 offset:49152
    ds_read_b128 a[212:215], v17 offset:49152
    v_mfma_f32_16x16x32_bf16 v[200:203], a[188:191], v[80:83], v[200:203]
    v_exp_f32 v107, v107
    v_mfma_f32_16x16x32_bf16 v[204:207], a[188:191], v[84:87], v[204:207]
    v_cvt_pk_bf16_f32 v66, v104, v105
    v_cvt_pk_bf16_f32 v67, v106, v107
    v_mfma_f32_16x16x32_bf16 v[208:211], a[188:191], v[88:91], v[208:211]
    v_exp_f32 v108, v108
    v_mfma_f32_16x16x32_bf16 v[212:215], a[188:191], v[92:95], v[212:215]
    s_waitcnt lgkmcnt(6)
    v_exp_f32 v109, v109
    v_mfma_f32_16x16x32_bf16 v[232:235], a[192:195], v[92:95], v[232:235]
    v_lshl_add_u32 v27, v0, 4, s43
    s_xor_b32 s43, s36, 1
    v_mfma_f32_16x16x32_bf16 v[228:231], a[192:195], v[88:91], v[228:231]
    s_mul_i32 s43, s43, 5120
    buffer_load_dwordx4 v9, s[16:19], s38 offen offset:3072 lds
    v_mfma_f32_16x16x32_bf16 v[224:227], a[192:195], v[84:87], v[224:227]
    v_exp_f32 v110, v110
    v_mfma_f32_16x16x32_bf16 v[220:223], a[192:195], v[80:83], v[220:223]
    v_exp_f32 v111, v111
    v_mfma_f32_16x16x32_bf16 v[216:219], a[192:195], v[76:79], v[216:219]
    s_waitcnt lgkmcnt(4)
    v_lshl_add_u32 v26, v0, 4, s43
    v_cvt_pk_bf16_f32 v70, v108, v109
    v_mfma_f32_16x16x32_bf16 v[236:239], a[196:199], v[76:79], v[236:239]
    s_lshl_b32 s43, s36, 9
    v_exp_f32 v112, v112
    v_mfma_f32_16x16x32_bf16 v[240:243], a[196:199], v[80:83], v[240:243]
    s_add_u32 s43, s43, 40960
    v_lshlrev_b32 v34, 2, v0
    v_cvt_pk_bf16_f32 v71, v110, v111
    v_mfma_f32_16x16x32_bf16 v[244:247], a[196:199], v[84:87], v[244:247]
    v_and_b32 v1, 15, v0
    v_lshl_add_u32 v1, v1, 2, s43
    v_mfma_f32_16x16x32_bf16 v[248:251], a[196:199], v[88:91], v[248:251]
    s_mov_b32 s45, 0x53800000
    v_exp_f32 v113, v113
    v_mfma_f32_16x16x32_bf16 v[252:255], a[196:199], v[92:95], v[252:255]
    s_waitcnt lgkmcnt(0)
    buffer_load_dword v32, v34, s[8:11], 0 offen offset:0 sc1
    v_mfma_f32_16x16x32_bf16 v[76:79], a[200:203], a[80:83], v[36:39]
    s_mov_b32 s46, 0x2b800000
    v_exp_f32 v114, v114
    v_mfma_f32_16x16x32_bf16 v[76:79], a[204:207], a[100:103], v[76:79]
    v_exp_f32 v115, v115
    v_mfma_f32_16x16x32_bf16 v[76:79], a[208:211], a[120:123], v[76:79]
    buffer_load_dword v2, v3, s[20:23], s39 offen offset:0
    v_mfma_f32_16x16x32_bf16 v[76:79], a[212:215], a[140:143], v[76:79]
    s_add_u32 s39, s39, 0x10000
    v_cvt_pk_bf16_f32 v74, v112, v113
    v_cvt_pk_bf16_f32 v75, v114, v115
    v_mfma_f32_16x16x32_bf16 v[80:83], a[200:203], a[84:87], v[40:43]
    ds_read_b128 a[216:219], v14 offset:53248
    ds_read_b128 a[184:187], v15 offset:53248
    v_mfma_f32_16x16x32_bf16 v[80:83], a[204:207], a[104:107], v[80:83]
    ds_read_b128 a[188:191], v16 offset:53248
    ds_read_b128 a[192:195], v17 offset:53248
    v_mfma_f32_16x16x32_bf16 v[80:83], a[208:211], a[124:127], v[80:83]
    v_mfma_f32_16x16x32_bf16 v[80:83], a[212:215], a[144:147], v[80:83]
    v_mfma_f32_16x16x32_bf16 v[84:87], a[200:203], a[88:91], v[44:47]
    v_exp_f32 v76, v76
    v_mfma_f32_16x16x32_bf16 v[84:87], a[204:207], a[108:111], v[84:87]
    s_add_u32 m0, s37, 0x1c000
    v_exp_f32 v77, v77
    v_mfma_f32_16x16x32_bf16 v[84:87], a[208:211], a[128:131], v[84:87]
    s_mov_b32 s38, 0xa000
    v_exp_f32 v78, v78
    v_mfma_f32_16x16x32_bf16 v[84:87], a[212:215], a[148:151], v[84:87]
    v_exp_f32 v79, v79
    v_mfma_f32_16x16x32_bf16 v[88:91], a[200:203], a[92:95], v[48:51]
    buffer_load_dwordx4 v4, s[12:15], s38 offen offset:0 lds
    v_mfma_f32_16x16x32_bf16 v[88:91], a[204:207], a[112:115], v[88:91]
    v_exp_f32 v80, v80
    v_mfma_f32_16x16x32_bf16 v[88:91], a[208:211], a[132:135], v[88:91]
    v_exp_f32 v81, v81
    v_mfma_f32_16x16x32_bf16 v[88:91], a[212:215], a[152:155], v[88:91]
    v_exp_f32 v82, v82
    v_mfma_f32_16x16x32_bf16 v[92:95], a[200:203], a[96:99], v[52:55]
    v_exp_f32 v83, v83
    v_mfma_f32_16x16x32_bf16 v[92:95], a[204:207], a[116:119], v[92:95]
    v_exp_f32 v84, v84
    v_mfma_f32_16x16x32_bf16 v[92:95], a[208:211], a[136:139], v[92:95]
    v_exp_f32 v85, v85
    v_mfma_f32_16x16x32_bf16 v[92:95], a[212:215], a[156:159], v[92:95]
    s_waitcnt lgkmcnt(0)
    v_exp_f32 v86, v86
    v_mfma_f32_16x16x32_bf16 v[96:99], a[216:219], a[80:83], v[36:39]
    v_exp_f32 v87, v87
    v_mfma_f32_16x16x32_bf16 v[96:99], a[184:187], a[100:103], v[96:99]
    v_exp_f32 v88, v88
    v_mfma_f32_16x16x32_bf16 v[96:99], a[188:191], a[120:123], v[96:99]
    buffer_load_dwordx4 v5, s[12:15], s38 offen offset:1024 lds
    v_mfma_f32_16x16x32_bf16 v[96:99], a[192:195], a[140:143], v[96:99]
    v_exp_f32 v89, v89
    v_mfma_f32_16x16x32_bf16 v[100:103], a[216:219], a[84:87], v[40:43]
    v_exp_f32 v90, v90
    v_mfma_f32_16x16x32_bf16 v[100:103], a[184:187], a[104:107], v[100:103]
    v_exp_f32 v91, v91
    v_mfma_f32_16x16x32_bf16 v[100:103], a[188:191], a[124:127], v[100:103]
    v_exp_f32 v92, v92
    v_mfma_f32_16x16x32_bf16 v[100:103], a[192:195], a[144:147], v[100:103]
    v_exp_f32 v93, v93
    v_mfma_f32_16x16x32_bf16 v[104:107], a[216:219], a[88:91], v[44:47]
    v_exp_f32 v94, v94
    v_mfma_f32_16x16x32_bf16 v[104:107], a[184:187], a[108:111], v[104:107]
    v_cvt_pk_bf16_f32 v76, v76, v77
    v_cvt_pk_bf16_f32 v77, v78, v79
    v_mfma_f32_16x16x32_bf16 v[104:107], a[188:191], a[128:131], v[104:107]
    v_exp_f32 v95, v95
    v_mfma_f32_16x16x32_bf16 v[104:107], a[192:195], a[148:151], v[104:107]
    buffer_load_dwordx4 v6, s[12:15], s38 offen offset:2048 lds
    v_mfma_f32_16x16x32_bf16 v[108:111], a[216:219], a[92:95], v[48:51]
    v_cvt_pk_bf16_f32 v80, v80, v81
    v_cvt_pk_bf16_f32 v81, v82, v83
    v_mfma_f32_16x16x32_bf16 v[108:111], a[184:187], a[112:115], v[108:111]
    s_waitcnt vmcnt(9) lgkmcnt(0)
    s_barrier
    v_mfma_f32_16x16x32_bf16 v[108:111], a[188:191], a[132:135], v[108:111]
    ds_read_b64_tr_b16 a[196:197], v18 offset:32768
    ds_read_b64_tr_b16 a[198:199], v18 offset:36864
    v_mfma_f32_16x16x32_bf16 v[108:111], a[192:195], a[152:155], v[108:111]
    v_exp_f32 v96, v96
    v_mfma_f32_16x16x32_bf16 v[112:115], a[216:219], a[96:99], v[52:55]
    v_cvt_pk_bf16_f32 v84, v84, v85
    v_cvt_pk_bf16_f32 v85, v86, v87
    v_mfma_f32_16x16x32_bf16 v[112:115], a[184:187], a[116:119], v[112:115]
    v_exp_f32 v97, v97
    v_mfma_f32_16x16x32_bf16 v[112:115], a[188:191], a[136:139], v[112:115]
    ds_read_b64_tr_b16 a[200:201], v19 offset:32768
    ds_read_b64_tr_b16 a[202:203], v19 offset:36864
    v_mfma_f32_16x16x32_bf16 v[112:115], a[192:195], a[156:159], v[112:115]
    v_cvt_pk_bf16_f32 v88, v88, v89
    v_cvt_pk_bf16_f32 v89, v90, v91
    v_mfma_f32_16x16x32_bf16 a[160:163], a[180:183], v[56:59], a[160:163]
    buffer_load_dwordx4 v7, s[12:15], s38 offen offset:3072 lds
    v_mfma_f32_16x16x32_bf16 a[164:167], a[180:183], v[60:63], a[164:167]
    v_exp_f32 v98, v98
    v_mfma_f32_16x16x32_bf16 a[168:171], a[180:183], v[64:67], a[168:171]
    v_cvt_pk_bf16_f32 v92, v92, v93
    v_cvt_pk_bf16_f32 v93, v94, v95
    v_mfma_f32_16x16x32_bf16 a[172:175], a[180:183], v[68:71], a[172:175]
    ds_read_b64_tr_b16 a[204:205], v20 offset:32768
    ds_read_b64_tr_b16 a[206:207], v20 offset:36864
    v_mfma_f32_16x16x32_bf16 a[176:179], a[180:183], v[72:75], a[176:179]
    s_waitcnt lgkmcnt(4)
    v_exp_f32 v99, v99
    v_mfma_f32_16x16x32_bf16 v[132:135], a[196:199], v[72:75], v[132:135]
    v_cvt_pk_bf16_f32 v78, v96, v97
    v_cvt_pk_bf16_f32 v79, v98, v99
    v_mfma_f32_16x16x32_bf16 v[128:131], a[196:199], v[68:71], v[128:131]
    s_add_u32 m0, s37, 0x14000
    v_exp_f32 v100, v100
    v_mfma_f32_16x16x32_bf16 v[124:127], a[196:199], v[64:67], v[124:127]
    s_mov_b32 s38, 0x8000
    v_exp_f32 v101, v101
    v_mfma_f32_16x16x32_bf16 v[120:123], a[196:199], v[60:63], v[120:123]
    ds_read_b64_tr_b16 a[208:209], v21 offset:32768
    ds_read_b64_tr_b16 a[210:211], v21 offset:36864
    v_mfma_f32_16x16x32_bf16 v[116:119], a[196:199], v[56:59], v[116:119]
    s_waitcnt lgkmcnt(4)
    buffer_load_dwordx4 v8, s[16:19], s38 offen offset:0 lds
    v_mfma_f32_16x16x32_bf16 v[136:139], a[200:203], v[56:59], v[136:139]
    v_exp_f32 v102, v102
    v_mfma_f32_16x16x32_bf16 v[140:143], a[200:203], v[60:63], v[140:143]
    v_exp_f32 v103, v103
    v_mfma_f32_16x16x32_bf16 v[144:147], a[200:203], v[64:67], v[144:147]
    v_cvt_pk_bf16_f32 v82, v100, v101
    v_cvt_pk_bf16_f32 v83, v102, v103
    v_mfma_f32_16x16x32_bf16 v[148:151], a[200:203], v[68:71], v[148:151]
    ds_read_b64_tr_b16 a[212:213], v22 offset:32768
    ds_read_b64_tr_b16 a[214:215], v22 offset:36864
    v_mfma_f32_16x16x32_bf16 v[152:155], a[200:203], v[72:75], v[152:155]
    s_waitcnt lgkmcnt(4)
    v_exp_f32 v104, v104
    v_mfma_f32_16x16x32_bf16 v[172:175], a[204:207], v[72:75], v[172:175]
    v_exp_f32 v105, v105
    v_mfma_f32_16x16x32_bf16 v[168:171], a[204:207], v[68:71], v[168:171]
    v_exp_f32 v106, v106
    v_mfma_f32_16x16x32_bf16 v[164:167], a[204:207], v[64:67], v[164:167]
    v_exp_f32 v107, v107
    v_mfma_f32_16x16x32_bf16 v[160:163], a[204:207], v[60:63], v[160:163]
    buffer_load_dwordx4 v9, s[16:19], s38 offen offset:1024 lds
    v_mfma_f32_16x16x32_bf16 v[156:159], a[204:207], v[56:59], v[156:159]
    s_waitcnt lgkmcnt(2)
    ds_read_b64_tr_b16 a[216:217], v23 offset:32768
    ds_read_b64_tr_b16 a[218:219], v23 offset:36864
    v_mfma_f32_16x16x32_bf16 a[220:223], a[208:211], v[56:59], a[220:223]
L_hop2:
    s_cbranch_execz L_hop3
    v_cvt_pk_bf16_f32 v86, v104, v105
    v_cvt_pk_bf16_f32 v87, v106, v107
    v_mfma_f32_16x16x32_bf16 a[224:227], a[208:211], v[60:63], a[224:227]
    v_exp_f32 v108, v108
    v_mfma_f32_16x16x32_bf16 a[228:231], a[208:211], v[64:67], a[228:231]
    v_exp_f32 v109, v109
    v_mfma_f32_16x16x32_bf16 a[232:235], a[208:211], v[68:71], a[232:235]
    ds_read_b64_tr_b16 a[184:185], v24 offset:32768
    ds_read_b64_tr_b16 a[186:187], v24 offset:36864
    v_mfma_f32_16x16x32_bf16 a[236:239], a[208:211], v[72:75], a[236:239]
    s_waitcnt lgkmcnt(4)
    v_exp_f32 v110, v110
    v_mfma_f32_16x16x32_bf16 v[192:195], a[212:215], v[72:75], v[192:195]
    v_exp_f32 v111, v111
    v_mfma_f32_16x16x32_bf16 v[188:191], a[212:215], v[68:71], v[188:191]
    v_cvt_pk_bf16_f32 v90, v108, v109
    v_cvt_pk_bf16_f32 v91, v110, v111
    v_mfma_f32_16x16x32_bf16 v[184:187], a[212:215], v[64:67], v[184:187]
    v_exp_f32 v112, v112
    v_mfma_f32_16x16x32_bf16 v[180:183], a[212:215], v[60:63], v[180:183]
    buffer_load_dwordx4 v8, s[16:19], s38 offen offset:2048 lds
    v_mfma_f32_16x16x32_bf16 v[176:179], a[212:215], v[56:59], v[176:179]
    s_waitcnt lgkmcnt(2)
    ds_read_b64_tr_b16 a[188:189], v25 offset:32768
    ds_read_b64_tr_b16 a[190:191], v25 offset:36864
    v_mfma_f32_16x16x32_bf16 v[196:199], a[216:219], v[56:59], v[196:199]
    ds_read_b128 a[192:195], v14 offset:0
    ds_read_b128 a[196:199], v15 offset:0
    v_mfma_f32_16x16x32_bf16 v[200:203], a[216:219], v[60:63], v[200:203]
    ds_read_b128 a[200:203], v16 offset:0
    ds_read_b128 a[204:207], v17 offset:0
    v_mfma_f32_16x16x32_bf16 v[204:207], a[216:219], v[64:67], v[204:207]
    v_exp_f32 v113, v113
    v_mfma_f32_16x16x32_bf16 v[208:211], a[216:219], v[68:71], v[208:211]
    v_exp_f32 v114, v114
    v_mfma_f32_16x16x32_bf16 v[212:215], a[216:219], v[72:75], v[212:215]
    s_waitcnt lgkmcnt(6)
    v_exp_f32 v115, v115
    v_mfma_f32_16x16x32_bf16 v[232:235], a[184:187], v[72:75], v[232:235]
    v_cvt_pk_bf16_f32 v94, v112, v113
    v_cvt_pk_bf16_f32 v95, v114, v115
    v_mfma_f32_16x16x32_bf16 v[228:231], a[184:187], v[68:71], v[228:231]
    v_mfma_f32_16x16x32_bf16 v[224:227], a[184:187], v[64:67], v[224:227]
    buffer_load_dwordx4 v9, s[16:19], s38 offen offset:3072 lds
    v_mfma_f32_16x16x32_bf16 v[220:223], a[184:187], v[60:63], v[220:223]
    v_mfma_f32_16x16x32_bf16 v[216:219], a[184:187], v[56:59], v[216:219]
    s_waitcnt lgkmcnt(4)
    v_mfma_f32_16x16x32_bf16 v[236:239], a[188:191], v[56:59], v[236:239]
    v_mfma_f32_16x16x32_bf16 v[240:243], a[188:191], v[60:63], v[240:243]
    v_mfma_f32_16x16x32_bf16 v[244:247], a[188:191], v[64:67], v[244:247]
    v_mfma_f32_16x16x32_bf16 v[248:251], a[188:191], v[68:71], v[248:251]
    v_mfma_f32_16x16x32_bf16 v[252:255], a[188:191], v[72:75], v[252:255]
    s_waitcnt lgkmcnt(0)
    v_mfma_f32_16x16x32_bf16 v[56:59], a[192:195], a[80:83], v[36:39]
    buffer_load_dword v2, v3, s[20:23], s39 offen offset:0
    v_mfma_f32_16x16x32_bf16 v[56:59], a[196:199], a[100:103], v[56:59]
    s_add_u32 s39, s39, 0x10000
    v_mfma_f32_16x16x32_bf16 v[56:59], a[200:203], a[120:123], v[56:59]
    v_mfma_f32_16x16x32_bf16 v[56:59], a[204:207], a[140:143], v[56:59]
    v_mfma_f32_16x16x32_bf16 v[60:63], a[192:195], a[84:87], v[40:43]
    ds_read_b128 a[208:211], v14 offset:4096
    ds_read_b128 a[212:215], v15 offset:4096
    v_mfma_f32_16x16x32_bf16 v[60:63], a[196:199], a[104:107], v[60:63]
    ds_read_b128 a[216:219], v16 offset:4096
    ds_read_b128 a[184:187], v17 offset:4096
    v_mfma_f32_16x16x32_bf16 v[60:63], a[200:203], a[124:127], v[60:63]
    v_mfma_f32_16x16x32_bf16 v[60:63], a[204:207], a[144:147], v[60:63]
    s_add_u32 m0, s37, 0x24000
    v_mfma_f32_16x16x32_bf16 v[64:67], a[192:195], a[88:91], v[44:47]
    s_mov_b32 s38, 0xc000
    v_exp_f32 v56, v56
    v_mfma_f32_16x16x32_bf16 v[64:67], a[196:199], a[108:111], v[64:67]
    v_exp_f32 v57, v57
    v_mfma_f32_16x16x32_bf16 v[64:67], a[200:203], a[128:131], v[64:67]
    buffer_load_dwordx4 v4, s[12:15], s38 offen offset:0 lds
    v_mfma_f32_16x16x32_bf16 v[64:67], a[204:207], a[148:151], v[64:67]
    v_exp_f32 v58, v58
    v_mfma_f32_16x16x32_bf16 v[68:71], a[192:195], a[92:95], v[48:51]
    v_exp_f32 v59, v59
    v_mfma_f32_16x16x32_bf16 v[68:71], a[196:199], a[112:115], v[68:71]
    v_exp_f32 v60, v60
    v_mfma_f32_16x16x32_bf16 v[68:71], a[200:203], a[132:135], v[68:71]
    v_exp_f32 v61, v61
    v_mfma_f32_16x16x32_bf16 v[68:71], a[204:207], a[152:155], v[68:71]
    v_exp_f32 v62, v62
    v_mfma_f32_16x16x32_bf16 v[72:75], a[192:195], a[96:99], v[52:55]
    v_exp_f32 v63, v63
    v_mfma_f32_16x16x32_bf16 v[72:75], a[196:199], a[116:119], v[72:75]
    s_lshl_b32 s43, s76, 2
    v_exp_f32 v64, v64
    v_mfma_f32_16x16x32_bf16 v[72:75], a[200:203], a[136:139], v[72:75]
    s_add_u32 s81, s43, s36
    v_exp_f32 v65, v65
    v_mfma_f32_16x16x32_bf16 v[72:75], a[204:207], a[156:159], v[72:75]
    s_waitcnt lgkmcnt(0)
    buffer_load_dwordx4 v5, s[12:15], s38 offen offset:1024 lds
    v_mfma_f32_16x16x32_bf16 v[96:99], a[208:211], a[80:83], v[36:39]
    s_lshr_b32 s43, s78, 3
    v_exp_f32 v66, v66
    v_mfma_f32_16x16x32_bf16 v[96:99], a[212:215], a[100:103], v[96:99]
    v_exp_f32 v67, v67
    v_mfma_f32_16x16x32_bf16 v[96:99], a[216:219], a[120:123], v[96:99]
    v_exp_f32 v68, v68
    v_mfma_f32_16x16x32_bf16 v[96:99], a[184:187], a[140:143], v[96:99]
    v_exp_f32 v69, v69
    v_mfma_f32_16x16x32_bf16 v[100:103], a[208:211], a[84:87], v[40:43]
    v_exp_f32 v70, v70
    v_mfma_f32_16x16x32_bf16 v[100:103], a[212:215], a[104:107], v[100:103]
    v_exp_f32 v71, v71
    v_mfma_f32_16x16x32_bf16 v[100:103], a[216:219], a[124:127], v[100:103]
    v_exp_f32 v72, v72
    v_mfma_f32_16x16x32_bf16 v[100:103], a[184:187], a[144:147], v[100:103]
    v_exp_f32 v73, v73
    v_mfma_f32_16x16x32_bf16 v[104:107], a[208:211], a[88:91], v[44:47]
    v_exp_f32 v74, v74
    v_mfma_f32_16x16x32_bf16 v[104:107], a[212:215], a[108:111], v[104:107]
    buffer_load_dwordx4 v6, s[12:15], s38 offen offset:2048 lds
    v_mfma_f32_16x16x32_bf16 v[104:107], a[216:219], a[128:131], v[104:107]
    s_waitcnt vmcnt(13)
    v_readlane_b32 s44, v32, 0
    v_readlane_b32 s80, v32, s81
    v_mfma_f32_16x16x32_bf16 v[104:107], a[184:187], a[148:151], v[104:107]
    s_lshl_b32 s43, s43, 12
    v_cvt_pk_bf16_f32 v56, v56, v57
    v_cvt_pk_bf16_f32 v57, v58, v59
    v_mfma_f32_16x16x32_bf16 v[108:111], a[208:211], a[92:95], v[48:51]
    v_exp_f32 v75, v75
    v_mfma_f32_16x16x32_bf16 v[108:111], a[212:215], a[112:115], v[108:111]
    s_waitcnt vmcnt(8) lgkmcnt(0)
    s_barrier
    v_mfma_f32_16x16x32_bf16 v[108:111], a[216:219], a[132:135], v[108:111]
    ds_read_b64_tr_b16 a[188:189], v18 offset:0
    ds_read_b64_tr_b16 a[190:191], v18 offset:4096
    v_mfma_f32_16x16x32_bf16 v[108:111], a[184:187], a[152:155], v[108:111]
L_again:
    s_and_b32 s47, s44, s80
    s_cbranch_scc0 L_wait_ready
    v_cvt_pk_bf16_f32 v60, v60, v61
    v_mfma_f32_16x16x32_bf16 v[112:115], a[208:211], a[96:99], v[52:55]
    s_and_b32 s44, s44, 7
    v_exp_f32 v96, v96
    v_mfma_f32_16x16x32_bf16 v[112:115], a[212:215], a[116:119], v[112:115]
    v_cvt_pk_bf16_f32 v61, v62, v63
    v_cvt_pk_bf16_f32 v64, v64, v65
    v_mfma_f32_16x16x32_bf16 v[112:115], a[216:219], a[136:139], v[112:115]
    buffer_load_dwordx4 v7, s[12:15], s38 offen offset:3072 lds
    v_mfma_f32_16x16x32_bf16 v[112:115], a[184:187], a[156:159], v[112:115]
    ds_read_b64_tr_b16 a[192:193], v19 offset:0
    ds_read_b64_tr_b16 a[194:195], v19 offset:4096
    v_mfma_f32_16x16x32_bf16 a[160:163], a[180:183], v[76:79], a[160:163]
    v_exp_f32 v97, v97
    v_mfma_f32_16x16x32_bf16 a[164:167], a[180:183], v[80:83], a[164:167]
    s_cmp_lg_u32 s44, s82
    s_cbranch_scc1 L_rerot
    v_cvt_pk_bf16_f32 v65, v66, v67
    v_mfma_f32_16x16x32_bf16 a[168:171], a[180:183], v[84:87], a[168:171]
    s_and_b32 s47, s78, 7
    v_cvt_pk_bf16_f32 v68, v68, v69
    v_cvt_pk_bf16_f32 v69, v70, v71
    v_mfma_f32_16x16x32_bf16 a[172:175], a[180:183], v[88:91], a[172:175]
    s_lshl_b32 s47, s47, 9
    ds_read_b64_tr_b16 a[196:197], v20 offset:0
    ds_read_b64_tr_b16 a[198:199], v20 offset:4096
    v_mfma_f32_16x16x32_bf16 a[176:179], a[180:183], v[92:95], a[176:179]
    s_waitcnt lgkmcnt(4)
    s_add_u32 m0, s37, 0xc000
    v_cvt_pk_bf16_f32 v72, v72, v73
    v_mfma_f32_16x16x32_bf16 v[132:135], a[188:191], v[92:95], v[132:135]
    s_mov_b32 s38, 0xa000
    v_exp_f32 v98, v98
    v_mfma_f32_16x16x32_bf16 v[128:131], a[188:191], v[88:91], v[128:131]
    s_and_b32 s80, s80, 8
    v_exp_f32 v99, v99
    v_mfma_f32_16x16x32_bf16 v[124:127], a[188:191], v[84:87], v[124:127]
    s_lshl_b32 s80, s80, 10
    buffer_load_dwordx4 v8, s[16:19], s38 offen offset:0 lds
    v_mfma_f32_16x16x32_bf16 v[120:123], a[188:191], v[80:83], v[120:123]
    s_add_u32 s43, s43, s47
    ds_read_b64_tr_b16 a[200:201], v21 offset:0
    ds_read_b64_tr_b16 a[202:203], v21 offset:4096
    v_mfma_f32_16x16x32_bf16 v[116:119], a[188:191], v[76:79], v[116:119]
    s_waitcnt lgkmcnt(4)
    v_cvt_pk_bf16_f32 v73, v74, v75
    v_cvt_pk_bf16_f32 v58, v96, v97
    v_mfma_f32_16x16x32_bf16 v[136:139], a[192:195], v[76:79], v[136:139]
    s_add_u32 s35, s43, s80
    v_exp_f32 v100, v100
    v_mfma_f32_16x16x32_bf16 v[140:143], a[192:195], v[80:83], v[140:143]
    v_cvt_pk_bf16_f32 v59, v98, v99
    v_and_b32 v32, 7, v0
    v_mfma_f32_16x16x32_bf16 v[144:147], a[192:195], v[84:87], v[144:147]
    v_exp_f32 v101, v101
    v_mfma_f32_16x16x32_bf16 v[148:151], a[192:195], v[88:91], v[148:151]
    ds_read_b64_tr_b16 a[204:205], v22 offset:0
    ds_read_b64_tr_b16 a[206:207], v22 offset:4096
    v_mfma_f32_16x16x32_bf16 v[152:155], a[192:195], v[92:95], v[152:155]
    s_waitcnt lgkmcnt(4)
    v_lshl_add_u32 v34, v32, 4, s35
    v_lshrrev_b32 v32, 4, v0
    v_mfma_f32_16x16x32_bf16 v[172:175], a[196:199], v[92:95], v[172:175]
    v_exp_f32 v102, v102
    v_mfma_f32_16x16x32_bf16 v[168:171], a[196:199], v[88:91], v[168:171]
    buffer_load_dwordx4 v9, s[16:19], s38 offen offset:1024 lds
    v_mfma_f32_16x16x32_bf16 v[164:167], a[196:199], v[84:87], v[164:167]
    v_lshl_add_u32 v34, v32, 7, v34
    v_bfe_u32 v32, v0, 3, 1
    v_mfma_f32_16x16x32_bf16 v[160:163], a[196:199], v[80:83], v[160:163]
    ds_read_b64_tr_b16 a[208:209], v23 offset:0
    ds_read_b64_tr_b16 a[210:211], v23 offset:4096
    v_mfma_f32_16x16x32_bf16 v[156:159], a[196:199], v[76:79], v[156:159]
    s_waitcnt lgkmcnt(4)
    v_exp_f32 v103, v103
    v_mfma_f32_16x16x32_bf16 a[220:223], a[200:203], v[76:79], a[220:223]
    v_lshl_add_u32 v34, v32, 14, v34
    v_cvt_pk_bf16_f32 v62, v100, v101
    v_mfma_f32_16x16x32_bf16 a[224:227], a[200:203], v[80:83], a[224:227]
    v_exp_f32 v104, v104
    v_mfma_f32_16x16x32_bf16 a[228:231], a[200:203], v[84:87], a[228:231]
    v_exp_f32 v105, v105
    v_mfma_f32_16x16x32_bf16 a[232:235], a[200:203], v[88:91], a[232:235]
    ds_read_b64_tr_b16 a[212:213], v24 offset:0
    ds_read_b64_tr_b16 a[214:215], v24 offset:4096
    v_mfma_f32_16x16x32_bf16 a[236:239], a[200:203], v[92:95], a[236:239]
    s_waitcnt lgkmcnt(4)
    v_cvt_pk_bf16_f32 v63, v102, v103
    v_cvt_pk_bf16_f32 v66, v104, v105
    v_mfma_f32_16x16x32_bf16 v[192:195], a[204:207], v[92:95], v[192:195]
    buffer_load_dwordx4 v8, s[16:19], s38 offen offset:2048 lds
    v_mfma_f32_16x16x32_bf16 v[188:191], a[204:207], v[88:91], v[188:191]
    v_exp_f32 v106, v106
    v_mfma_f32_16x16x32_bf16 v[184:187], a[204:207], v[84:87], v[184:187]
    v_exp_f32 v107, v107
    v_mfma_f32_16x16x32_bf16 v[180:183], a[204:207], v[80:83], v[180:183]
    ds_read_b64_tr_b16 a[216:217], v25 offset:0
    ds_read_b64_tr_b16 a[218:219], v25 offset:4096
    v_mfma_f32_16x16x32_bf16 v[176:179], a[204:207], v[76:79], v[176:179]
    s_waitcnt lgkmcnt(4)
    ds_read_b128 a[184:187], v14 offset:16384
    ds_read_b128 a[188:191], v15 offset:16384
    v_mfma_f32_16x16x32_bf16 v[196:199], a[208:211], v[76:79], v[196:199]
    ds_read_b128 a[192:195], v16 offset:16384
    ds_read_b128 a[196:199], v17 offset:16384
    v_mfma_f32_16x16x32_bf16 v[200:203], a[208:211], v[80:83], v[200:203]
    v_exp_f32 v108, v108
    v_mfma_f32_16x16x32_bf16 v[204:207], a[208:211], v[84:87], v[204:207]
    v_exp_f32 v109, v109
    v_mfma_f32_16x16x32_bf16 v[208:211], a[208:211], v[88:91], v[208:211]
    v_cvt_pk_bf16_f32 v67, v106, v107
    v_cvt_pk_bf16_f32 v70, v108, v109
    v_mfma_f32_16x16x32_bf16 v[212:215], a[208:211], v[92:95], v[212:215]
    s_waitcnt lgkmcnt(6)
    v_exp_f32 v110, v110
    v_mfma_f32_16x16x32_bf16 v[232:235], a[212:215], v[92:95], v[232:235]
    buffer_load_dwordx4 v9, s[16:19], s38 offen offset:3072 lds
    v_mfma_f32_16x16x32_bf16 v[228:231], a[212:215], v[88:91], v[228:231]
    v_exp_f32 v111, v111
    v_mfma_f32_16x16x32_bf16 v[224:227], a[212:215], v[84:87], v[224:227]
    v_exp_f32 v112, v112
    v_mfma_f32_16x16x32_bf16 v[220:223], a[212:215], v[80:83], v[220:223]
    v_exp_f32 v113, v113
    v_mfma_f32_16x16x32_bf16 v[216:219], a[212:215], v[76:79], v[216:219]
    s_waitcnt lgkmcnt(4)
    v_cvt_pk_bf16_f32 v71, v110, v111
    v_cvt_pk_bf16_f32 v74, v112, v113
    v_mfma_f32_16x16x32_bf16 v[236:239], a[216:219], v[76:79], v[236:239]
    v_exp_f32 v114, v114
    v_mfma_f32_16x16x32_bf16 v[240:243], a[216:219], v[80:83], v[240:243]
    v_exp_f32 v115, v115
    v_mfma_f32_16x16x32_bf16 v[244:247], a[216:219], v[84:87], v[244:247]
    v_cvt_pk_bf16_f32 v75, v114, v115
    v_mfma_f32_16x16x32_bf16 v[248:251], a[216:219], v[88:91], v[248:251]
    buffer_load_dword v2, v3, s[20:23], s39 offen offset:0
    v_mfma_f32_16x16x32_bf16 v[252:255], a[216:219], v[92:95], v[252:255]
    s_waitcnt lgkmcnt(0)
    s_add_u32 s39, s39, 0x10000
    v_mfma_f32_16x16x32_bf16 v[76:79], a[184:187], a[80:83], v[36:39]
    v_mfma_f32_16x16x32_bf16 v[76:79], a[188:191], a[100:103], v[76:79]
    v_mfma_f32_16x16x32_bf16 v[76:79], a[192:195], a[120:123], v[76:79]
    v_mfma_f32_16x16x32_bf16 v[76:79], a[196:199], a[140:143], v[76:79]
    v_mfma_f32_16x16x32_bf16 v[80:83], a[184:187], a[84:87], v[40:43]
    ds_read_b128 a[200:203], v14 offset:20480
    ds_read_b128 a[204:207], v15 offset:20480
    v_mfma_f32_16x16x32_bf16 v[80:83], a[188:191], a[104:107], v[80:83]
    s_add_u32 m0, s37, 0x18000
    ds_read_b128 a[208:211], v16 offset:20480
    ds_read_b128 a[212:215], v17 offset:20480
    v_mfma_f32_16x16x32_bf16 v[80:83], a[192:195], a[124:127], v[80:83]
    s_mov_b32 s38, 0xe000
    v_mfma_f32_16x16x32_bf16 v[80:83], a[196:199], a[144:147], v[80:83]
    v_mfma_f32_16x16x32_bf16 v[84:87], a[184:187], a[88:91], v[44:47]
    buffer_load_dwordx4 v4, s[12:15], s38 offen offset:0 lds
    v_mfma_f32_16x16x32_bf16 v[84:87], a[188:191], a[108:111], v[84:87]
    v_exp_f32 v76, v76
    v_mfma_f32_16x16x32_bf16 v[84:87], a[192:195], a[128:131], v[84:87]
    v_exp_f32 v77, v77
    v_mfma_f32_16x16x32_bf16 v[84:87], a[196:199], a[148:151], v[84:87]
    v_exp_f32 v78, v78
    v_mfma_f32_16x16x32_bf16 v[88:91], a[184:187], a[92:95], v[48:51]
    v_exp_f32 v79, v79
    v_mfma_f32_16x16x32_bf16 v[88:91], a[188:191], a[112:115], v[88:91]
    v_exp_f32 v80, v80
    v_mfma_f32_16x16x32_bf16 v[88:91], a[192:195], a[132:135], v[88:91]
    v_exp_f32 v81, v81
    v_mfma_f32_16x16x32_bf16 v[88:91], a[196:199], a[152:155], v[88:91]
    v_exp_f32 v82, v82
    v_mfma_f32_16x16x32_bf16 v[92:95], a[184:187], a[96:99], v[52:55]
    v_exp_f32 v83, v83
    v_mfma_f32_16x16x32_bf16 v[92:95], a[188:191], a[116:119], v[92:95]
    buffer_load_dwordx4 v5, s[12:15], s38 offen offset:1024 lds
    v_mfma_f32_16x16x32_bf16 v[92:95], a[192:195], a[136:139], v[92:95]
    v_exp_f32 v84, v84
    v_mfma_f32_16x16x32_bf16 v[92:95], a[196:199], a[156:159], v[92:95]
    s_waitcnt lgkmcnt(0)
    v_exp_f32 v85, v85
    v_mfma_f32_16x16x32_bf16 v[96:99], a[200:203], a[80:83], v[36:39]
    v_exp_f32 v86, v86
    v_mfma_f32_16x16x32_bf16 v[96:99], a[204:207], a[100:103], v[96:99]
    v_exp_f32 v87, v87
    v_mfma_f32_16x16x32_bf16 v[96:99], a[208:211], a[120:123], v[96:99]
    v_exp_f32 v88, v88
    v_mfma_f32_16x16x32_bf16 v[96:99], a[212:215], a[140:143], v[96:99]
    v_exp_f32 v89, v89
    v_mfma_f32_16x16x32_bf16 v[100:103], a[200:203], a[84:87], v[40:43]
    v_exp_f32 v90, v90
    v_mfma_f32_16x16x32_bf16 v[100:103], a[204:207], a[104:107], v[100:103]
    v_exp_f32 v91, v91
    v_mfma_f32_16x16x32_bf16 v[100:103], a[208:211], a[124:127], v[100:103]
    buffer_load_dwordx4 v6, s[12:15], s38 offen offset:2048 lds
    v_mfma_f32_16x16x32_bf16 v[100:103], a[212:215], a[144:147], v[100:103]
    v_exp_f32 v92, v92
    v_mfma_f32_16x16x32_bf16 v[104:107], a[200:203], a[88:91], v[44:47]
    v_exp_f32 v93, v93
    v_mfma_f32_16x16x32_bf16 v[104:107], a[204:207], a[108:111], v[104:107]
    v_exp_f32 v94, v94
    v_mfma_f32_16x16x32_bf16 v[104:107], a[208:211], a[128:131], v[104:107]
    v_cvt_pk_bf16_f32 v76, v76, v77
    v_cvt_pk_bf16_f32 v77, v78, v79
    v_mfma_f32_16x16x32_bf16 v[104:107], a[212:215], a[148:151], v[104:107]
    v_exp_f32 v95, v95
    v_mfma_f32_16x16x32_bf16 v[108:111], a[200:203], a[92:95], v[48:51]
    v_cvt_pk_bf16_f32 v80, v80, v81
    v_cvt_pk_bf16_f32 v81, v82, v83
    v_mfma_f32_16x16x32_bf16 v[108:111], a[204:207], a[112:115], v[108:111]
    s_waitcnt vmcnt(8) lgkmcnt(0)
    s_barrier
    v_mfma_f32_16x16x32_bf16 v[108:111], a[208:211], a[132:135], v[108:111]
    ds_read_b64_tr_b16 a[216:217], v18 offset:49152
    ds_read_b64_tr_b16 a[218:219], v18 offset:53248
    v_mfma_f32_16x16x32_bf16 v[108:111], a[212:215], a[152:155], v[108:111]
    v_exp_f32 v96, v96
    v_mfma_f32_16x16x32_bf16 v[112:115], a[200:203], a[96:99], v[52:55]
    buffer_load_dwordx4 v7, s[12:15], s38 offen offset:3072 lds
    v_mfma_f32_16x16x32_bf16 v[112:115], a[204:207], a[116:119], v[112:115]
    v_cvt_pk_bf16_f32 v84, v84, v85
    v_cvt_pk_bf16_f32 v85, v86, v87
    v_mfma_f32_16x16x32_bf16 v[112:115], a[208:211], a[136:139], v[112:115]
    ds_read_b64_tr_b16 a[184:185], v19 offset:49152
    ds_read_b64_tr_b16 a[186:187], v19 offset:53248
    v_mfma_f32_16x16x32_bf16 v[112:115], a[212:215], a[156:159], v[112:115]
    v_exp_f32 v97, v97
    v_mfma_f32_16x16x32_bf16 a[160:163], a[180:183], v[56:59], a[160:163]
    v_cvt_pk_bf16_f32 v88, v88, v89
    v_cvt_pk_bf16_f32 v89, v90, v91
    v_mfma_f32_16x16x32_bf16 a[164:167], a[180:183], v[60:63], a[164:167]
    v_exp_f32 v98, v98
    v_mfma_f32_16x16x32_bf16 a[168:171], a[180:183], v[64:67], a[168:171]
    v_cvt_pk_bf16_f32 v92, v92, v93
    v_cvt_pk_bf16_f32 v93, v94, v95
    v_mfma_f32_16x16x32_bf16 a[172:175], a[180:183], v[68:71], a[172:175]
    ds_read_b64_tr_b16 a[188:189], v20 offset:49152
    ds_read_b64_tr_b16 a[190:191], v20 offset:53248
    v_mfma_f32_16x16x32_bf16 a[176:179], a[180:183], v[72:75], a[176:179]
    s_waitcnt lgkmcnt(4)
    buffer_load_dword v2, v3, s[20:23], s39 offen offset:0
    v_mfma_f32_16x16x32_bf16 v[132:135], a[216:219], v[72:75], v[132:135]
    s_add_u32 s39, s39, 0xfffd0200
    v_exp_f32 v99, v99
    v_mfma_f32_16x16x32_bf16 v[128:131], a[216:219], v[68:71], v[128:131]
    v_cvt_pk_bf16_f32 v78, v96, v97
    v_cvt_pk_bf16_f32 v79, v98, v99
    v_mfma_f32_16x16x32_bf16 v[124:127], a[216:219], v[64:67], v[124:127]
    v_exp_f32 v100, v100
    v_mfma_f32_16x16x32_bf16 v[120:123], a[216:219], v[60:63], v[120:123]
    ds_read_b64_tr_b16 a[192:193], v21 offset:49152
    ds_read_b64_tr_b16 a[194:195], v21 offset:53248
    v_mfma_f32_16x16x32_bf16 v[116:119], a[216:219], v[56:59], v[116:119]
    s_waitcnt lgkmcnt(4)
    v_exp_f32 v101, v101
    v_mfma_f32_16x16x32_bf16 v[136:139], a[184:187], v[56:59], v[136:139]
    v_exp_f32 v102, v102
    v_mfma_f32_16x16x32_bf16 v[140:143], a[184:187], v[60:63], v[140:143]
    s_add_u32 m0, s37, 0x10000
    v_exp_f32 v103, v103
    v_mfma_f32_16x16x32_bf16 v[144:147], a[184:187], v[64:67], v[144:147]
    s_mov_b32 s38, 0xc000
    v_cvt_pk_bf16_f32 v82, v100, v101
    v_cvt_pk_bf16_f32 v83, v102, v103
    v_mfma_f32_16x16x32_bf16 v[148:151], a[184:187], v[68:71], v[148:151]
    ds_read_b64_tr_b16 a[196:197], v22 offset:49152
    ds_read_b64_tr_b16 a[198:199], v22 offset:53248
    v_mfma_f32_16x16x32_bf16 v[152:155], a[184:187], v[72:75], v[152:155]
    s_waitcnt lgkmcnt(4)
    buffer_load_dwordx4 v8, s[16:19], s38 offen offset:0 lds
    v_mfma_f32_16x16x32_bf16 v[172:175], a[188:191], v[72:75], v[172:175]
    v_exp_f32 v104, v104
    v_mfma_f32_16x16x32_bf16 v[168:171], a[188:191], v[68:71], v[168:171]
    v_exp_f32 v105, v105
    v_mfma_f32_16x16x32_bf16 v[164:167], a[188:191], v[64:67], v[164:167]
    v_and_b32 v5, 15, v0
    v_lshrrev_b32 v4, 4, v0
    v_mfma_f32_16x16x32_bf16 v[160:163], a[188:191], v[60:63], v[160:163]
    ds_read_b64_tr_b16 a[200:201], v23 offset:49152
    ds_read_b64_tr_b16 a[202:203], v23 offset:53248
    v_mfma_f32_16x16x32_bf16 v[156:159], a[188:191], v[56:59], v[156:159]
    s_waitcnt lgkmcnt(4)
    v_exp_f32 v106, v106
    v_mfma_f32_16x16x32_bf16 a[220:223], a[192:195], v[56:59], a[220:223]
    v_lshlrev_b32 v4, 2, v4
    v_sub_u32 v4, v5, v4
    v_mfma_f32_16x16x32_bf16 a[224:227], a[192:195], v[60:63], a[224:227]
    buffer_load_dwordx4 v9, s[16:19], s38 offen offset:1024 lds
    v_mfma_f32_16x16x32_bf16 a[228:231], a[192:195], v[64:67], a[228:231]
    v_exp_f32 v107, v107
    v_mfma_f32_16x16x32_bf16 a[232:235], a[192:195], v[68:71], a[232:235]
    ds_read_b64_tr_b16 a[204:205], v24 offset:49152
    ds_read_b64_tr_b16 a[206:207], v24 offset:53248
    v_mfma_f32_16x16x32_bf16 a[236:239], a[192:195], v[72:75], a[236:239]
    s_waitcnt lgkmcnt(4)
    v_cvt_pk_bf16_f32 v86, v104, v105
    v_and_b32 v5, 1, v4
    v_mfma_f32_16x16x32_bf16 v[192:195], a[196:199], v[72:75], v[192:195]
    v_exp_f32 v108, v108
    v_mfma_f32_16x16x32_bf16 v[188:191], a[196:199], v[68:71], v[188:191]
    v_cvt_pk_bf16_f32 v87, v106, v107
    v_lshlrev_b32 v5, 4, v5
    v_mfma_f32_16x16x32_bf16 v[184:187], a[196:199], v[64:67], v[184:187]
    s_mov_b32 s43, 0x3f80
    v_exp_f32 v109, v109
    v_mfma_f32_16x16x32_bf16 v[180:183], a[196:199], v[60:63], v[180:183]
    buffer_load_dwordx4 v8, s[16:19], s38 offen offset:2048 lds
    v_mfma_f32_16x16x32_bf16 v[176:179], a[196:199], v[56:59], v[176:179]
    s_waitcnt lgkmcnt(2)
    ds_read_b64_tr_b16 a[208:209], v25 offset:49152
    ds_read_b64_tr_b16 a[210:211], v25 offset:53248
    v_mfma_f32_16x16x32_bf16 v[196:199], a[200:203], v[56:59], v[196:199]
    ds_read_b128 a[212:215], v14 offset:49152
    ds_read_b128 a[216:219], v15 offset:49152
    v_mfma_f32_16x16x32_bf16 v[200:203], a[200:203], v[60:63], v[200:203]
    ds_read_b128 a[184:187], v16 offset:49152
    ds_read_b128 a[188:191], v17 offset:49152
    v_mfma_f32_16x16x32_bf16 v[204:207], a[200:203], v[64:67], v[204:207]
    v_lshlrev_b32 v5, v5, s43
    v_ashrrev_i32 v4, 1, v4
    v_mfma_f32_16x16x32_bf16 v[208:211], a[200:203], v[68:71], v[208:211]
    v_exp_f32 v110, v110
    v_mfma_f32_16x16x32_bf16 v[212:215], a[200:203], v[72:75], v[212:215]
    s_waitcnt lgkmcnt(6)
    v_cmp_eq_u32 s[66:67], 0, v4
    v_cmp_eq_u32 s[40:41], 1, v4
    v_mfma_f32_16x16x32_bf16 v[232:235], a[204:207], v[72:75], v[232:235]
    s_mov_b32 s43, 40960
    buffer_load_dwordx4 v9, s[16:19], s38 offen offset:3072 lds
    v_mfma_f32_16x16x32_bf16 v[228:231], a[204:207], v[68:71], v[228:231]
    v_exp_f32 v111, v111
    v_mfma_f32_16x16x32_bf16 v[224:227], a[204:207], v[64:67], v[224:227]
    v_cvt_pk_bf16_f32 v90, v108, v109
    v_cvt_pk_bf16_f32 v91, v110, v111
    v_mfma_f32_16x16x32_bf16 v[220:223], a[204:207], v[60:63], v[220:223]
    v_exp_f32 v112, v112
    v_mfma_f32_16x16x32_bf16 v[216:219], a[204:207], v[56:59], v[216:219]
    s_waitcnt lgkmcnt(4)
    v_cndmask_b32 v6, 0, v5, s[66:67]
    v_cndmask_b32 v7, 0, v5, s[40:41]
    v_mfma_f32_16x16x32_bf16 v[236:239], a[208:211], v[56:59], v[236:239]
    s_add_u32 m0, s37, 0x20000
    v_exp_f32 v113, v113
    v_mfma_f32_16x16x32_bf16 v[240:243], a[208:211], v[60:63], v[240:243]
    s_xor_b32 s38, s34, 0x0
    v_mov_b32 v4, 0
    v_mov_b32 v5, 0
    v_mfma_f32_16x16x32_bf16 v[244:247], a[208:211], v[64:67], v[244:247]
    buffer_load_dwordx4 v10, s[20:23], s38 offen offset:0 lds
    v_mfma_f32_16x16x32_bf16 v[248:251], a[208:211], v[68:71], v[248:251]
    v_and_b32 v33, 3, v0
    v_lshl_add_u32 v33, v33, 9, s43
    v_mfma_f32_16x16x32_bf16 v[252:255], a[208:211], v[72:75], v[252:255]
    s_waitcnt lgkmcnt(0)
    v_exp_f32 v114, v114
    v_mfma_f32_16x16x32_bf16 v[56:59], a[212:215], a[80:83], v[36:39]
    v_exp_f32 v115, v115
    v_mfma_f32_16x16x32_bf16 v[56:59], a[216:219], a[100:103], v[56:59]
    v_cvt_pk_bf16_f32 v94, v112, v113
    v_cvt_pk_bf16_f32 v95, v114, v115
    v_mfma_f32_16x16x32_bf16 v[56:59], a[184:187], a[120:123], v[56:59]
    v_mfma_f32_16x16x32_bf16 v[56:59], a[188:191], a[140:143], v[56:59]
    v_mfma_f32_16x16x32_bf16 v[60:63], a[212:215], a[84:87], v[40:43]
    buffer_load_dwordx4 v11, s[20:23], s38 offen offset:1024 lds
    v_mfma_f32_16x16x32_bf16 v[60:63], a[216:219], a[104:107], v[60:63]
    ds_read_b128 a[192:195], v14 offset:53248
    ds_read_b128 a[196:199], v15 offset:53248
    v_mfma_f32_16x16x32_bf16 v[60:63], a[184:187], a[124:127], v[60:63]
    ds_read_b128 a[200:203], v16 offset:53248
    ds_read_b128 a[204:207], v17 offset:53248
    v_mfma_f32_16x16x32_bf16 v[60:63], a[188:191], a[144:147], v[60:63]
    v_mfma_f32_16x16x32_bf16 v[64:67], a[212:215], a[88:91], v[44:47]
    v_exp_f32 v56, v56
    v_mfma_f32_16x16x32_bf16 v[64:67], a[216:219], a[108:111], v[64:67]
    v_exp_f32 v57, v57
    v_mfma_f32_16x16x32_bf16 v[64:67], a[184:187], a[128:131], v[64:67]
    v_exp_f32 v58, v58
    v_mfma_f32_16x16x32_bf16 v[64:67], a[188:191], a[148:151], v[64:67]
    buffer_load_dwordx4 v12, s[20:23], s38 offen offset:2048 lds
    v_mfma_f32_16x16x32_bf16 v[68:71], a[212:215], a[92:95], v[48:51]
    v_exp_f32 v59, v59
    v_mfma_f32_16x16x32_bf16 v[68:71], a[216:219], a[112:115], v[68:71]
    v_exp_f32 v60, v60
    v_mfma_f32_16x16x32_bf16 v[68:71], a[184:187], a[132:135], v[68:71]
    v_exp_f32 v61, v61
    v_mfma_f32_16x16x32_bf16 v[68:71], a[188:191], a[152:155], v[68:71]
    v_exp_f32 v62, v62
    v_mfma_f32_16x16x32_bf16 v[72:75], a[212:215], a[96:99], v[52:55]
    v_exp_f32 v63, v63
    v_mfma_f32_16x16x32_bf16 v[72:75], a[216:219], a[116:119], v[72:75]
    v_exp_f32 v64, v64
    v_mfma_f32_16x16x32_bf16 v[72:75], a[184:187], a[136:139], v[72:75]
    buffer_load_dwordx4 v13, s[20:23], s38 offen offset:3072 lds
    v_mfma_f32_16x16x32_bf16 v[72:75], a[188:191], a[156:159], v[72:75]
    s_waitcnt lgkmcnt(0)
    v_exp_f32 v65, v65
    v_mfma_f32_16x16x32_bf16 v[96:99], a[192:195], a[80:83], v[36:39]
    v_exp_f32 v66, v66
    v_mfma_f32_16x16x32_bf16 v[96:99], a[196:199], a[100:103], v[96:99]
    v_exp_f32 v67, v67
    v_mfma_f32_16x16x32_bf16 v[96:99], a[200:203], a[120:123], v[96:99]
    s_add_u32 m0, s37, 0x0
    v_exp_f32 v68, v68
    v_mfma_f32_16x16x32_bf16 v[96:99], a[204:207], a[140:143], v[96:99]
    s_xor_b32 s38, s34, 0x8000
    v_exp_f32 v69, v69
    v_mfma_f32_16x16x32_bf16 v[100:103], a[192:195], a[84:87], v[40:43]
    v_exp_f32 v70, v70
    v_mfma_f32_16x16x32_bf16 v[100:103], a[196:199], a[104:107], v[100:103]
    buffer_load_dwordx4 v10, s[20:23], s38 offen offset:0 lds
    v_mfma_f32_16x16x32_bf16 v[100:103], a[200:203], a[124:127], v[100:103]
    v_exp_f32 v71, v71
    v_mfma_f32_16x16x32_bf16 v[100:103], a[204:207], a[144:147], v[100:103]
    v_exp_f32 v72, v72
    v_mfma_f32_16x16x32_bf16 v[104:107], a[192:195], a[88:91], v[44:47]
    v_exp_f32 v73, v73
    v_mfma_f32_16x16x32_bf16 v[104:107], a[196:199], a[108:111], v[104:107]
    v_exp_f32 v74, v74
    v_mfma_f32_16x16x32_bf16 v[104:107], a[200:203], a[128:131], v[104:107]
    v_cvt_pk_bf16_f32 v56, v56, v57
    v_cvt_pk_bf16_f32 v57, v58, v59
    v_mfma_f32_16x16x32_bf16 v[104:107], a[204:207], a[148:151], v[104:107]
    v_exp_f32 v75, v75
    v_mfma_f32_16x16x32_bf16 v[108:111], a[192:195], a[92:95], v[48:51]
    buffer_load_dwordx4 v11, s[20:23], s38 offen offset:1024 lds
    v_mfma_f32_16x16x32_bf16 v[108:111], a[196:199], a[112:115], v[108:111]
    s_waitcnt vmcnt(11) lgkmcnt(0)
    s_barrier
    v_mfma_f32_16x16x32_bf16 v[108:111], a[200:203], a[132:135], v[108:111]
    ds_read_b64_tr_b16 a[208:209], v18 offset:16384
    ds_read_b64_tr_b16 a[210:211], v18 offset:20480
    v_mfma_f32_16x16x32_bf16 v[108:111], a[204:207], a[152:155], v[108:111]
    v_cvt_pk_bf16_f32 v60, v60, v61
    v_cvt_pk_bf16_f32 v61, v62, v63
    v_mfma_f32_16x16x32_bf16 v[112:115], a[192:195], a[96:99], v[52:55]
    v_exp_f32 v96, v96
    v_mfma_f32_16x16x32_bf16 v[112:115], a[196:199], a[116:119], v[112:115]
    v_cvt_pk_bf16_f32 v64, v64, v65
    v_cvt_pk_bf16_f32 v65, v66, v67
    v_mfma_f32_16x16x32_bf16 v[112:115], a[200:203], a[136:139], v[112:115]
    ds_read_b64_tr_b16 a[212:213], v19 offset:16384
    ds_read_b64_tr_b16 a[214:215], v19 offset:20480
    v_mfma_f32_16x16x32_bf16 v[112:115], a[204:207], a[156:159], v[112:115]
    buffer_load_dwordx4 v12, s[20:23], s38 offen offset:2048 lds
    v_mfma_f32_16x16x32_bf16 a[160:163], a[180:183], v[76:79], a[160:163]
    v_exp_f32 v97, v97
    v_mfma_f32_16x16x32_bf16 a[164:167], a[180:183], v[80:83], a[164:167]
    v_cvt_pk_bf16_f32 v68, v68, v69
    v_cvt_pk_bf16_f32 v69, v70, v71
    v_mfma_f32_16x16x32_bf16 a[168:171], a[180:183], v[84:87], a[168:171]
    v_exp_f32 v98, v98
    v_mfma_f32_16x16x32_bf16 a[172:175], a[180:183], v[88:91], a[172:175]
    ds_read_b64_tr_b16 a[216:217], v20 offset:16384
    ds_read_b64_tr_b16 a[218:219], v20 offset:20480
    v_mfma_f32_16x16x32_bf16 a[176:179], a[180:183], v[92:95], a[176:179]
    s_waitcnt lgkmcnt(4)
    v_cvt_pk_bf16_f32 v72, v72, v73
    v_cvt_pk_bf16_f32 v73, v74, v75
    v_mfma_f32_16x16x32_bf16 v[132:135], a[208:211], v[92:95], v[132:135]
    v_exp_f32 v99, v99
    v_mfma_f32_16x16x32_bf16 v[128:131], a[208:211], v[88:91], v[128:131]
    buffer_load_dwordx4 v13, s[20:23], s38 offen offset:3072 lds
    v_mfma_f32_16x16x32_bf16 v[124:127], a[208:211], v[84:87], v[124:127]
    v_cvt_pk_bf16_f32 v58, v96, v97
    v_cvt_pk_bf16_f32 v59, v98, v99
    v_mfma_f32_16x16x32_bf16 v[120:123], a[208:211], v[80:83], v[120:123]
L_hop3:
    s_cbranch_execz L_hop_ret
    ds_read_b64_tr_b16 a[184:185], v21 offset:16384
    ds_read_b64_tr_b16 a[186:187], v21 offset:20480
    v_mfma_f32_16x16x32_bf16 v[116:119], a[208:211], v[76:79], v[116:119]
    s_waitcnt lgkmcnt(4)
    v_exp_f32 v100, v100
    v_mfma_f32_16x16x32_bf16 v[136:139], a[212:215], v[76:79], v[136:139]
    s_add_u32 m0, s37, 0x14000
    v_exp_f32 v101, v101
    v_mfma_f32_16x16x32_bf16 v[140:143], a[212:215], v[80:83], v[140:143]
    s_mov_b32 s38, 0xe000
    v_exp_f32 v102, v102
    v_mfma_f32_16x16x32_bf16 v[144:147], a[212:215], v[84:87], v[144:147]
    v_exp_f32 v103, v103
    v_mfma_f32_16x16x32_bf16 v[148:151], a[212:215], v[88:91], v[148:151]
    buffer_load_dwordx4 v8, s[16:19], s38 offen offset:0 lds
    v_mfma_f32_16x16x32_bf16 v[152:155], a[212:215], v[92:95], v[152:155]
    s_waitcnt lgkmcnt(2)
    ds_read_b64_tr_b16 a[188:189], v22 offset:16384
    ds_read_b64_tr_b16 a[190:191], v22 offset:20480
    v_mfma_f32_16x16x32_bf16 v[172:175], a[216:219], v[92:95], v[172:175]
    v_cvt_pk_bf16_f32 v62, v100, v101
    v_cvt_pk_bf16_f32 v63, v102, v103
    v_mfma_f32_16x16x32_bf16 v[168:171], a[216:219], v[88:91], v[168:171]
    v_exp_f32 v104, v104
    v_mfma_f32_16x16x32_bf16 v[164:167], a[216:219], v[84:87], v[164:167]
    v_exp_f32 v105, v105
    v_mfma_f32_16x16x32_bf16 v[160:163], a[216:219], v[80:83], v[160:163]
    ds_read_b64_tr_b16 a[192:193], v23 offset:16384
    ds_read_b64_tr_b16 a[194:195], v23 offset:20480
    v_mfma_f32_16x16x32_bf16 v[156:159], a[216:219], v[76:79], v[156:159]
    s_waitcnt lgkmcnt(4)
    v_exp_f32 v106, v106
    v_mfma_f32_16x16x32_bf16 a[220:223], a[184:187], v[76:79], a[220:223]
    buffer_load_dwordx4 v9, s[16:19], s38 offen offset:1024 lds
    v_mfma_f32_16x16x32_bf16 a[224:227], a[184:187], v[80:83], a[224:227]
    v_exp_f32 v107, v107
    v_mfma_f32_16x16x32_bf16 a[228:231], a[184:187], v[84:87], a[228:231]
    v_cvt_pk_bf16_f32 v66, v104, v105
    v_cvt_pk_bf16_f32 v67, v106, v107
    v_mfma_f32_16x16x32_bf16 a[232:235], a[184:187], v[88:91], a[232:235]
    ds_read_b64_tr_b16 a[196:197], v24 offset:16384
    ds_read_b64_tr_b16 a[198:199], v24 offset:20480
    v_mfma_f32_16x16x32_bf16 a[236:239], a[184:187], v[92:95], a[236:239]
    s_waitcnt lgkmcnt(4)
    v_exp_f32 v108, v108
    v_mfma_f32_16x16x32_bf16 v[192:195], a[188:191], v[92:95], v[192:195]
    v_exp_f32 v109, v109
    v_mfma_f32_16x16x32_bf16 v[188:191], a[188:191], v[88:91], v[188:191]
    v_exp_f32 v110, v110
    v_mfma_f32_16x16x32_bf16 v[184:187], a[188:191], v[84:87], v[184:187]
    buffer_load_dwordx4 v8, s[16:19], s38 offen offset:2048 lds
    v_mfma_f32_16x16x32_bf16 v[180:183], a[188:191], v[80:83], v[180:183]
    ds_read_b64_tr_b16 a[200:201], v25 offset:16384
    ds_read_b64_tr_b16 a[202:203], v25 offset:20480
    v_mfma_f32_16x16x32_bf16 v[176:179], a[188:191], v[76:79], v[176:179]
    s_waitcnt lgkmcnt(4)
    ds_read_b128 a[204:207], v14 offset:0
    ds_read_b128 a[208:211], v15 offset:0
    v_mfma_f32_16x16x32_bf16 v[196:199], a[192:195], v[76:79], v[196:199]
    ds_read_b128 a[212:215], v16 offset:0
    ds_read_b128 a[216:219], v17 offset:0
    v_mfma_f32_16x16x32_bf16 v[200:203], a[192:195], v[80:83], v[200:203]
    v_exp_f32 v111, v111
    v_mfma_f32_16x16x32_bf16 v[204:207], a[192:195], v[84:87], v[204:207]
    v_cvt_pk_bf16_f32 v70, v108, v109
    v_cvt_pk_bf16_f32 v71, v110, v111
    v_mfma_f32_16x16x32_bf16 v[208:211], a[192:195], v[88:91], v[208:211]
    v_exp_f32 v112, v112
    v_mfma_f32_16x16x32_bf16 v[212:215], a[192:195], v[92:95], v[212:215]
    s_waitcnt lgkmcnt(6)
    buffer_load_dwordx4 v9, s[16:19], s38 offen offset:3072 lds
    v_mfma_f32_16x16x32_bf16 v[232:235], a[196:199], v[92:95], v[232:235]
    v_exp_f32 v113, v113
    v_mfma_f32_16x16x32_bf16 v[228:231], a[196:199], v[88:91], v[228:231]
    v_exp_f32 v114, v114
    v_mfma_f32_16x16x32_bf16 v[224:227], a[196:199], v[84:87], v[224:227]
    v_exp_f32 v115, v115
    v_mfma_f32_16x16x32_bf16 v[220:223], a[196:199], v[80:83], v[220:223]
    s_add_u32 m0, s37, 0x4000
    v_cvt_pk_bf16_f32 v74, v112, v113
    v_cvt_pk_bf16_f32 v75, v114, v115
    v_mfma_f32_16x16x32_bf16 v[216:219], a[196:199], v[76:79], v[216:219]
    s_waitcnt lgkmcnt(4)
    v_mov_b32 v8, 0
    v_mov_b32 v9, 0
    v_mfma_f32_16x16x32_bf16 v[236:239], a[200:203], v[76:79], v[236:239]
    s_xor_b32 s38, s34, 0x10000
    v_mfma_f32_16x16x32_bf16 v[240:243], a[200:203], v[80:83], v[240:243]
    buffer_load_dwordx4 v10, s[20:23], s38 offen offset:0 lds
    v_mfma_f32_16x16x32_bf16 v[244:247], a[200:203], v[84:87], v[244:247]
    v_mfma_f32_16x16x32_bf16 v[248:251], a[200:203], v[88:91], v[248:251]
    v_mfma_f32_16x16x32_bf16 v[252:255], a[200:203], v[92:95], v[252:255]
    s_waitcnt lgkmcnt(0)
    v_mfma_f32_16x16x32_bf16 v[76:79], a[204:207], a[80:83], v[36:39]
    v_mfma_f32_16x16x32_bf16 v[76:79], a[208:211], a[100:103], v[76:79]
    buffer_load_dwordx4 v11, s[20:23], s38 offen offset:1024 lds
    v_mfma_f32_16x16x32_bf16 v[76:79], a[212:215], a[120:123], v[76:79]
    s_waitcnt vmcnt(10)
    ds_read_b64_tr_b16 a[0:1], v28 offset:32768
    ds_read_b64_tr_b16 a[2:3], v28 offset:34816
    v_mfma_f32_16x16x32_bf16 v[76:79], a[216:219], a[140:143], v[76:79]
    v_add_u32 v28, 0xfffe8000, v28
    v_mfma_f32_16x16x32_bf16 v[80:83], a[204:207], a[84:87], v[40:43]
    ds_read_b64_tr_b16 a[4:5], v29 offset:32768
    ds_read_b64_tr_b16 a[6:7], v29 offset:34816
    v_mfma_f32_16x16x32_bf16 v[80:83], a[208:211], a[104:107], v[80:83]
    ds_read_b128 a[184:187], v14 offset:4096
    v_add_u32 v29, 0xfffe8000, v29
    v_mfma_f32_16x16x32_bf16 v[80:83], a[212:215], a[124:127], v[80:83]
    buffer_load_dwordx4 v12, s[20:23], s38 offen offset:2048 lds
    v_mfma_f32_16x16x32_bf16 v[80:83], a[216:219], a[144:147], v[80:83]
    ds_read_b64_tr_b16 a[8:9], v30 offset:32768
    ds_read_b64_tr_b16 a[10:11], v30 offset:34816
    v_mfma_f32_16x16x32_bf16 v[84:87], a[204:207], a[88:91], v[44:47]
    ds_read_b128 a[188:191], v15 offset:4096
    v_add_u32 v30, 0xfffe8000, v30
    v_mfma_f32_16x16x32_bf16 v[84:87], a[208:211], a[108:111], v[84:87]
    ds_read_b64_tr_b16 a[12:13], v31 offset:32768
    ds_read_b64_tr_b16 a[14:15], v31 offset:34816
    v_mfma_f32_16x16x32_bf16 v[84:87], a[212:215], a[128:131], v[84:87]
    ds_read_b128 a[192:195], v16 offset:4096
    ds_read_b128 a[196:199], v17 offset:4096
    v_mfma_f32_16x16x32_bf16 v[84:87], a[216:219], a[148:151], v[84:87]
    buffer_load_dwordx4 v13, s[20:23], s38 offen offset:3072 lds
    v_mfma_f32_16x16x32_bf16 v[88:91], a[204:207], a[92:95], v[48:51]
    v_exp_f32 v76, v76
    v_mfma_f32_16x16x32_bf16 v[88:91], a[208:211], a[112:115], v[88:91]
    s_add_u32 m0, s37, 0x1c000
    v_exp_f32 v77, v77
    v_mfma_f32_16x16x32_bf16 v[88:91], a[212:215], a[132:135], v[88:91]
    s_xor_b32 s38, s34, 0x18000
    v_add_u32 v31, 0xfffe8000, v31
    v_cvt_pk_bf16_f32 v76, v76, v77
    v_mfma_f32_16x16x32_bf16 v[88:91], a[216:219], a[152:155], v[88:91]
    v_exp_f32 v78, v78
    v_mfma_f32_16x16x32_bf16 v[92:95], a[204:207], a[96:99], v[52:55]
    buffer_load_dwordx4 v10, s[20:23], s38 offen offset:0 lds
    v_mfma_f32_16x16x32_bf16 v[92:95], a[208:211], a[116:119], v[92:95]
    v_exp_f32 v79, v79
    v_mfma_f32_16x16x32_bf16 v[92:95], a[212:215], a[136:139], v[92:95]
    v_exp_f32 v80, v80
    v_mfma_f32_16x16x32_bf16 v[92:95], a[216:219], a[156:159], v[92:95]
    s_waitcnt lgkmcnt(0)
    v_exp_f32 v81, v81
    v_mfma_f32_16x16x32_bf16 v[96:99], a[184:187], a[80:83], v[36:39]
    v_exp_f32 v82, v82
    v_mfma_f32_16x16x32_bf16 v[96:99], a[188:191], a[100:103], v[96:99]
    buffer_load_dwordx4 v11, s[20:23], s38 offen offset:1024 lds
    v_mfma_f32_16x16x32_bf16 v[96:99], a[192:195], a[120:123], v[96:99]
    s_waitcnt vmcnt(10)
    ds_read_b64_tr_b16 a[16:17], v28 offset:0
    ds_read_b64_tr_b16 a[18:19], v28 offset:2048
    v_mfma_f32_16x16x32_bf16 v[96:99], a[196:199], a[140:143], v[96:99]
    ds_read_b64_tr_b16 a[20:21], v29 offset:0
    ds_read_b64_tr_b16 a[22:23], v29 offset:2048
    v_mfma_f32_16x16x32_bf16 v[100:103], a[184:187], a[84:87], v[40:43]
    ds_read_b64_tr_b16 a[24:25], v30 offset:0
    ds_read_b64_tr_b16 a[26:27], v30 offset:2048
    v_mfma_f32_16x16x32_bf16 v[100:103], a[188:191], a[104:107], v[100:103]
    ds_read_b64_tr_b16 a[28:29], v31 offset:0
    ds_read_b64_tr_b16 a[30:31], v31 offset:2048
    v_mfma_f32_16x16x32_bf16 v[100:103], a[192:195], a[124:127], v[100:103]
    buffer_load_dwordx4 v12, s[20:23], s38 offen offset:2048 lds
    v_cvt_pk_bf16_f32 v77, v78, v79
    v_mfma_f32_16x16x32_bf16 v[100:103], a[196:199], a[144:147], v[100:103]
    v_exp_f32 v83, v83
    v_mfma_f32_16x16x32_bf16 v[104:107], a[184:187], a[88:91], v[44:47]
    v_exp_f32 v84, v84
    v_mfma_f32_16x16x32_bf16 v[104:107], a[188:191], a[108:111], v[104:107]
    v_exp_f32 v85, v85
    v_cvt_pk_bf16_f32 v80, v80, v81
    v_mfma_f32_16x16x32_bf16 v[104:107], a[192:195], a[128:131], v[104:107]
    v_exp_f32 v86, v86
    v_mfma_f32_16x16x32_bf16 v[104:107], a[196:199], a[148:151], v[104:107]
    buffer_load_dwordx4 v13, s[20:23], s38 offen offset:3072 lds
    v_mfma_f32_16x16x32_bf16 v[108:111], a[184:187], a[92:95], v[48:51]
    v_exp_f32 v87, v87
    v_cvt_pk_bf16_f32 v81, v82, v83
    v_mfma_f32_16x16x32_bf16 v[108:111], a[188:191], a[112:115], v[108:111]
    s_waitcnt lgkmcnt(0)
    s_barrier
    v_mfma_f32_16x16x32_bf16 v[108:111], a[192:195], a[132:135], v[108:111]
    s_add_u32 m0, s37, 0x24000
    s_xor_b32 s38, s34, 0x20000
    ds_read_b64_tr_b16 a[200:201], v21 offset:32768
    v_mfma_f32_16x16x32_bf16 v[108:111], a[196:199], a[152:155], v[108:111]
    ds_read_b64_tr_b16 a[202:203], v21 offset:36864
    v_exp_f32 v88, v88
    v_mfma_f32_16x16x32_bf16 v[112:115], a[184:187], a[96:99], v[52:55]
    buffer_load_dwordx4 v10, s[20:23], s38 offen offset:0 lds
    v_mfma_f32_16x16x32_bf16 v[112:115], a[188:191], a[116:119], v[112:115]
    v_exp_f32 v89, v89
    v_cvt_pk_bf16_f32 v84, v84, v85
    v_mfma_f32_16x16x32_bf16 v[112:115], a[192:195], a[136:139], v[112:115]
    ds_read_b64_tr_b16 a[204:205], v18 offset:32768
    ds_read_b64_tr_b16 a[206:207], v18 offset:36864
    v_mfma_f32_16x16x32_bf16 v[112:115], a[196:199], a[156:159], v[112:115]
    v_exp_f32 v90, v90
    v_cvt_pk_bf16_f32 v85, v86, v87
    v_mfma_f32_16x16x32_bf16 a[160:163], a[180:183], v[56:59], a[160:163]
    buffer_load_dwordx4 v11, s[20:23], s38 offen offset:1024 lds
    v_mfma_f32_16x16x32_bf16 a[164:167], a[180:183], v[60:63], a[164:167]
    v_exp_f32 v91, v91
    v_cvt_pk_bf16_f32 v88, v88, v89
    v_mfma_f32_16x16x32_bf16 a[168:171], a[180:183], v[64:67], a[168:171]
    v_exp_f32 v92, v92
    v_cvt_pk_bf16_f32 v89, v90, v91
    v_mfma_f32_16x16x32_bf16 a[172:175], a[180:183], v[68:71], a[172:175]
    ds_read_b64_tr_b16 a[208:209], v19 offset:32768
    ds_read_b64_tr_b16 a[210:211], v19 offset:36864
    v_lshlrev_b32 v14, 4, v0
    v_mfma_f32_16x16x32_bf16 a[176:179], a[180:183], v[72:75], a[176:179]
    s_waitcnt lgkmcnt(4)
    buffer_load_dwordx4 v12, s[20:23], s38 offen offset:2048 lds
    v_xor_b32 v16, 0x200, v1
    v_mfma_f32_16x16x32_bf16 a[236:239], a[200:203], v[72:75], a[236:239]
    v_exp_f32 v93, v93
    v_mfma_f32_16x16x32_bf16 a[232:235], a[200:203], v[68:71], a[232:235]
    v_exp_f32 v94, v94
    v_cvt_pk_bf16_f32 v92, v92, v93
    v_mfma_f32_16x16x32_bf16 a[228:231], a[200:203], v[64:67], a[228:231]
    v_exp_f32 v95, v95
    v_mfma_f32_16x16x32_bf16 a[224:227], a[200:203], v[60:63], a[224:227]
    buffer_load_dwordx4 v13, s[20:23], s38 offen offset:3072 lds
    v_mfma_f32_16x16x32_bf16 a[220:223], a[200:203], v[56:59], a[220:223]
    s_waitcnt lgkmcnt(2)
    s_add_u32 m0, s37, 0x20000
    ds_read_b64_tr_b16 a[212:213], v20 offset:32768
    v_mfma_f32_16x16x32_bf16 v[116:119], a[204:207], v[56:59], v[116:119]
    s_xor_b32 s38, s34, 0x28000
    ds_read_b64_tr_b16 a[214:215], v20 offset:36864
    v_exp_f32 v96, v96
    v_mfma_f32_16x16x32_bf16 v[120:123], a[204:207], v[60:63], v[120:123]
    v_exp_f32 v97, v97
    v_cvt_pk_bf16_f32 v93, v94, v95
    v_mfma_f32_16x16x32_bf16 v[124:127], a[204:207], v[64:67], v[124:127]
    s_waitcnt vmcnt(8)
    buffer_load_dwordx4 v10, s[20:23], s38 offen offset:0 lds
    ds_read_b64_tr_b16 a[32:33], v28 offset:16384
    v_mfma_f32_16x16x32_bf16 v[128:131], a[204:207], v[68:71], v[128:131]
    ds_read_b64_tr_b16 a[34:35], v28 offset:18432
    ds_read_b64_tr_b16 a[216:217], v22 offset:32768
    v_add_u32 v28, 0x18000, v28
    v_mfma_f32_16x16x32_bf16 v[132:135], a[204:207], v[72:75], v[132:135]
    s_waitcnt lgkmcnt(5)
    ds_read_b64_tr_b16 a[36:37], v29 offset:16384
    ds_read_b64_tr_b16 a[38:39], v29 offset:18432
    v_add_u32 v29, 0x18000, v29
    v_mfma_f32_16x16x32_bf16 v[152:155], a[208:211], v[72:75], v[152:155]
    ds_read_b64_tr_b16 a[40:41], v30 offset:16384
    ds_read_b64_tr_b16 a[42:43], v30 offset:18432
    v_add_u32 v30, 0x18000, v30
    v_mfma_f32_16x16x32_bf16 v[148:151], a[208:211], v[68:71], v[148:151]
    buffer_load_dwordx4 v11, s[20:23], s38 offen offset:1024 lds
    ds_read_b64_tr_b16 a[44:45], v31 offset:16384
    v_mfma_f32_16x16x32_bf16 v[144:147], a[208:211], v[64:67], v[144:147]
    ds_read_b64_tr_b16 a[218:219], v22 offset:36864
    ds_read_b64_tr_b16 a[46:47], v31 offset:18432
    v_add_u32 v31, 0x18000, v31
    v_mfma_f32_16x16x32_bf16 v[140:143], a[208:211], v[60:63], v[140:143]
    ds_read_b64_tr_b16 a[184:185], v23 offset:32768
    ds_read_b64_tr_b16 a[186:187], v23 offset:36864
    v_cvt_pk_bf16_f32 v78, v96, v97
    v_mfma_f32_16x16x32_bf16 v[136:139], a[208:211], v[56:59], v[136:139]
    s_waitcnt lgkmcnt(12)
    v_exp_f32 v98, v98
    v_accvgpr_read_b32 v36, a220
    v_mfma_f32_16x16x32_bf16 v[156:159], a[212:215], v[56:59], v[156:159]
    buffer_load_dwordx4 v12, s[20:23], s38 offen offset:2048 lds
    v_accvgpr_read_b32 v37, a221
    v_mfma_f32_16x16x32_bf16 v[160:163], a[212:215], v[60:63], v[160:163]
    v_exp_f32 v99, v99
    v_accvgpr_read_b32 v38, a222
    v_mfma_f32_16x16x32_bf16 v[164:167], a[212:215], v[64:67], v[164:167]
    v_cvt_pk_bf16_f32 v79, v98, v99
    v_exp_f32 v100, v100
    v_mfma_f32_16x16x32_bf16 v[168:171], a[212:215], v[68:71], v[168:171]
    ds_read_b64_tr_b16 a[188:189], v24 offset:32768
    ds_read_b64_tr_b16 a[190:191], v24 offset:36864
    s_waitcnt lgkmcnt(4)
    s_barrier
    v_mfma_f32_16x16x32_bf16 v[172:175], a[212:215], v[72:75], v[172:175]
    buffer_load_dwordx4 v13, s[20:23], s38 offen offset:3072 lds
    ds_read_b64_tr_b16 a[112:113], v22 offset:49152
    ds_read_b64_tr_b16 a[114:115], v22 offset:53248
    v_mfma_f32_16x16x32_bf16 v[192:195], a[216:219], v[72:75], v[192:195]
    s_add_u32 m0, s37, 0x18000
    ds_read_b64_tr_b16 a[116:117], v23 offset:49152
    ds_read_b64_tr_b16 a[118:119], v23 offset:53248
    v_accvgpr_read_b32 v39, a223
    v_mfma_f32_16x16x32_bf16 v[188:191], a[216:219], v[68:71], v[188:191]
    s_waitcnt vmcnt(8)
    s_xor_b32 s38, s34, 0x30000
    ds_read_b64_tr_b16 a[48:49], v28 offset:16384
    ds_read_b64_tr_b16 a[50:51], v28 offset:18432
    ds_read_b64_tr_b16 a[52:53], v29 offset:16384
    v_mfma_f32_16x16x32_bf16 v[184:187], a[216:219], v[64:67], v[184:187]
    ds_read_b64_tr_b16 a[54:55], v29 offset:18432
    ds_read_b64_tr_b16 a[120:121], v24 offset:49152
    ds_read_b64_tr_b16 a[56:57], v30 offset:16384
    v_mfma_f32_16x16x32_bf16 v[180:183], a[216:219], v[60:63], v[180:183]
    buffer_load_dwordx4 v10, s[20:23], s38 offen offset:0 lds
    ds_read_b64_tr_b16 a[122:123], v24 offset:53248
    ds_read_b64_tr_b16 a[58:59], v30 offset:18432
    v_mfma_f32_16x16x32_bf16 v[176:179], a[216:219], v[56:59], v[176:179]
    s_waitcnt lgkmcnt(14)
    ds_read_b64_tr_b16 a[124:125], v25 offset:49152
    ds_read_b64_tr_b16 a[60:61], v31 offset:16384
    ds_read_b64_tr_b16 a[126:127], v25 offset:53248
    ds_read_b64_tr_b16 a[62:63], v31 offset:18432
    v_mfma_f32_16x16x32_bf16 v[196:199], a[184:187], v[56:59], v[196:199]
    ds_read_b64_tr_b16 a[192:193], v25 offset:32768
    ds_read_b64_tr_b16 a[194:195], v25 offset:36864
    ds_read_b64_tr_b16 a[128:129], v18 offset:49152
    v_mfma_f32_16x16x32_bf16 v[200:203], a[184:187], v[60:63], v[200:203]
    ds_read_b64_tr_b16 a[130:131], v18 offset:53248
    ds_read_b64_tr_b16 a[132:133], v19 offset:49152
    ds_read_b64_tr_b16 a[134:135], v19 offset:53248
    ds_read_b64_tr_b16 a[136:137], v20 offset:49152
    v_mfma_f32_16x16x32_bf16 v[204:207], a[184:187], v[64:67], v[204:207]
    buffer_load_dwordx4 v11, s[20:23], s38 offen offset:1024 lds
    ds_read_b64_tr_b16 a[138:139], v20 offset:53248
    ds_read_b64_tr_b16 a[140:141], v21 offset:49152
    v_mfma_f32_16x16x32_bf16 v[208:211], a[184:187], v[68:71], v[208:211]
    ds_read_b64_tr_b16 a[142:143], v21 offset:53248
    v_exp_f32 v101, v101
    v_mfma_f32_16x16x32_bf16 v[212:215], a[184:187], v[72:75], v[212:215]
    s_waitcnt lgkmcnt(15)
    v_exp_f32 v102, v102
    v_exp_f32 v103, v103
    v_mfma_f32_16x16x32_bf16 v[232:235], a[188:191], v[72:75], v[232:235]
    v_cvt_pk_bf16_f32 v82, v100, v101
    v_exp_f32 v104, v104
    v_cvt_pk_bf16_f32 v83, v102, v103
    v_mfma_f32_16x16x32_bf16 v[228:231], a[188:191], v[68:71], v[228:231]
    buffer_load_dwordx4 v12, s[20:23], s38 offen offset:2048 lds
    v_accvgpr_read_b32 v40, a224
    v_mfma_f32_16x16x32_bf16 v[224:227], a[188:191], v[64:67], v[224:227]
    v_exp_f32 v105, v105
    v_exp_f32 v106, v106
    v_mfma_f32_16x16x32_bf16 v[220:223], a[188:191], v[60:63], v[220:223]
    s_waitcnt vmcnt(7)
    ds_read_b64_tr_b16 a[64:65], v28 offset:49152
    ds_read_b64_tr_b16 a[66:67], v28 offset:51200
    ds_read_b64_tr_b16 a[68:69], v29 offset:49152
    ds_read_b64_tr_b16 a[70:71], v29 offset:51200
    v_mfma_f32_16x16x32_bf16 v[216:219], a[188:191], v[56:59], v[216:219]
    s_waitcnt lgkmcnt(12)
    ds_read_b64_tr_b16 a[72:73], v30 offset:49152
    ds_read_b64_tr_b16 a[74:75], v30 offset:51200
    ds_read_b64_tr_b16 a[76:77], v31 offset:49152
    v_mfma_f32_16x16x32_bf16 v[236:239], a[192:195], v[56:59], v[236:239]
    buffer_load_dwordx4 v13, s[20:23], s38 offen offset:3072 lds
    ds_read_b64_tr_b16 a[78:79], v31 offset:51200
    v_cvt_pk_bf16_f32 v86, v104, v105
    v_mfma_f32_16x16x32_bf16 v[240:243], a[192:195], v[60:63], v[240:243]
    s_add_u32 m0, s37, 0xc000
    v_exp_f32 v107, v107
    v_exp_f32 v108, v108
    v_mfma_f32_16x16x32_bf16 v[244:247], a[192:195], v[64:67], v[244:247]
    s_xor_b32 s38, s34, 0x38000
    v_cvt_pk_bf16_f32 v87, v106, v107
    v_exp_f32 v109, v109
    v_mfma_f32_16x16x32_bf16 v[248:251], a[192:195], v[68:71], v[248:251]
    v_exp_f32 v110, v110
    v_exp_f32 v111, v111
    v_mfma_f32_16x16x32_bf16 v[252:255], a[192:195], v[72:75], v[252:255]
    buffer_load_dwordx4 v10, s[20:23], s38 offen offset:0 lds
    v_cvt_pk_bf16_f32 v90, v108, v109
    v_mfma_f32_16x16x32_bf16 v[176:179], a[112:115], v[76:79], v[176:179]
    v_exp_f32 v112, v112
    v_cvt_pk_bf16_f32 v91, v110, v111
    v_accvgpr_read_b32 v41, a225
    v_mfma_f32_16x16x32_bf16 v[196:199], a[116:119], v[76:79], v[196:199]
    v_exp_f32 v113, v113
    v_exp_f32 v114, v114
    v_mfma_f32_16x16x32_bf16 v[216:219], a[120:123], v[76:79], v[216:219]
    v_exp_f32 v115, v115
    v_cvt_pk_bf16_f32 v94, v112, v113
    v_mfma_f32_16x16x32_bf16 v[236:239], a[124:127], v[76:79], v[236:239]
    buffer_load_dwordx4 v11, s[20:23], s38 offen offset:1024 lds
    v_cvt_pk_bf16_f32 v95, v114, v115
    v_accvgpr_read_b32 v42, a226
    v_mfma_f32_16x16x32_bf16 a[160:163], a[180:183], v[76:79], a[160:163]
    s_waitcnt lgkmcnt(8)
    v_accvgpr_read_b32 v43, a227
    v_accvgpr_read_b32 v44, a228
    v_accvgpr_read_b32 v45, a229
    v_accvgpr_read_b32 v46, a230
    v_mfma_f32_16x16x32_bf16 v[116:119], a[128:131], v[76:79], v[116:119]
    v_cvt_pk_bf16_f32 v176, v176, v177
    v_cvt_pk_bf16_f32 v177, v178, v179
    v_accvgpr_read_b32 v47, a231
    v_mfma_f32_16x16x32_bf16 v[136:139], a[132:135], v[76:79], v[136:139]
    v_cvt_pk_bf16_f32 v178, v196, v197
    v_cvt_pk_bf16_f32 v179, v198, v199
    v_accvgpr_read_b32 v48, a232
    v_accvgpr_read_b32 v49, a233
    v_mfma_f32_16x16x32_bf16 v[156:159], a[136:139], v[76:79], v[156:159]
    s_waitcnt vmcnt(6)
    buffer_load_dwordx4 v12, s[20:23], s38 offen offset:2048 lds
    ds_write_b128 v27, v[176:179] offset:0
    v_mfma_f32_16x16x32_bf16 v[36:39], a[140:143], v[76:79], v[36:39]
    ds_read_b64_tr_b16 a[240:241], v28 offset:32768
    v_cvt_pk_bf16_f32 v216, v216, v217
    v_cvt_pk_bf16_f32 v217, v218, v219
    v_mfma_f32_16x16x32_bf16 v[180:183], a[112:115], v[80:83], v[180:183]
    ds_read_b64_tr_b16 a[242:243], v28 offset:34816
    ds_read_b64_tr_b16 a[244:245], v29 offset:32768
    v_cvt_pk_bf16_f32 v218, v236, v237
    v_cvt_pk_bf16_f32 v219, v238, v239
    v_mfma_f32_16x16x32_bf16 v[200:203], a[116:119], v[80:83], v[200:203]
    ds_read_b64_tr_b16 a[246:247], v29 offset:34816
    ds_read_b64_tr_b16 a[248:249], v30 offset:32768
    ds_read_b64_tr_b16 a[250:251], v30 offset:34816
    ds_read_b64_tr_b16 a[252:253], v31 offset:32768
    v_mfma_f32_16x16x32_bf16 v[220:223], a[120:123], v[80:83], v[220:223]
    buffer_load_dwordx4 v13, s[20:23], s38 offen offset:3072 lds
    v_accvgpr_read_b32 v56, a160
    v_mfma_f32_16x16x32_bf16 v[240:243], a[124:127], v[80:83], v[240:243]
    ds_write_b128 v27, v[216:219] offset:20480
    ds_read_b64_tr_b16 a[254:255], v31 offset:34816
    v_accvgpr_read_b32 v50, a234
    v_mfma_f32_16x16x32_bf16 v[184:187], a[112:115], v[84:87], v[184:187]
    ds_write_b32 v1, v56 offset:0
    v_accvgpr_read_b32 v51, a235
    v_accvgpr_read_b32 v52, a236
    v_mfma_f32_16x16x32_bf16 v[204:207], a[116:119], v[84:87], v[204:207]
    v_cvt_pk_bf16_f32 v180, v180, v181
    v_cvt_pk_bf16_f32 v181, v182, v183
    v_accvgpr_read_b32 v53, a237
    v_mfma_f32_16x16x32_bf16 v[224:227], a[120:123], v[84:87], v[224:227]
    buffer_load_dword v2, v3, s[20:23], s39 offen offset:0
    s_add_u32 s39, s39, 0x10000
    v_accvgpr_read_b32 v54, a238
    v_mfma_f32_16x16x32_bf16 v[244:247], a[124:127], v[84:87], v[244:247]
    v_cvt_pk_bf16_f32 v182, v200, v201
    v_cvt_pk_bf16_f32 v183, v202, v203
    v_accvgpr_read_b32 v55, a239
    v_mfma_f32_16x16x32_bf16 v[188:191], a[112:115], v[88:91], v[188:191]
    ds_write_b128 v27, v[180:183] offset:1024
    v_cvt_pk_bf16_f32 v220, v220, v221
    v_cvt_pk_bf16_f32 v221, v222, v223
    v_mfma_f32_16x16x32_bf16 v[208:211], a[116:119], v[88:91], v[208:211]
    s_waitcnt lgkmcnt(1)
    s_barrier
    ds_read_b128 a[144:147], v26 offset:0
    buffer_load_dword v2, v3, s[20:23], s39 offen offset:0
    v_mfma_f32_16x16x32_bf16 v[228:231], a[120:123], v[88:91], v[228:231]
    s_add_u32 s39, s39, 0x10000
    ds_read_b128 a[148:151], v26 offset:20480
    ds_read_b32 v64, v16 offset:0
    v_cvt_pk_bf16_f32 v222, v240, v241
    v_cvt_pk_bf16_f32 v223, v242, v243
    v_mfma_f32_16x16x32_bf16 v[248:251], a[124:127], v[88:91], v[248:251]
    ds_write_b128 v27, v[220:223] offset:21504
    v_cvt_pk_bf16_f32 v184, v184, v185
    v_cvt_pk_bf16_f32 v185, v186, v187
    v_mfma_f32_16x16x32_bf16 v[192:195], a[112:115], v[92:95], v[192:195]
    v_cvt_pk_bf16_f32 v186, v204, v205
    v_cvt_pk_bf16_f32 v187, v206, v207
    v_mfma_f32_16x16x32_bf16 v[212:215], a[116:119], v[92:95], v[212:215]
    buffer_load_dword v2, v3, s[20:23], s39 offen offset:0
    ds_write_b128 v27, v[184:187] offset:2048
    v_mfma_f32_16x16x32_bf16 v[232:235], a[120:123], v[92:95], v[232:235]
    s_add_u32 s39, s39, 0x10000
    v_cvt_pk_bf16_f32 v224, v224, v225
    v_cvt_pk_bf16_f32 v225, v226, v227
    v_cvt_pk_bf16_f32 v226, v244, v245
    v_cvt_pk_bf16_f32 v227, v246, v247
    v_mfma_f32_16x16x32_bf16 v[252:255], a[124:127], v[92:95], v[252:255]
    s_waitcnt vmcnt(7) lgkmcnt(4)
    ds_read_b64_tr_b16 v[176:177], v28 offset:0
    ds_read_b64_tr_b16 v[178:179], v28 offset:2048
    ds_write_b128 v27, v[224:227] offset:22528
    v_mfma_f32_16x16x32_bf16 v[116:119], v[6:9], a[144:147], v[116:119]
    s_waitcnt lgkmcnt(5)
    v_add_f32 v64, v56, v64
    v_rcp_f32 v70, v64
    v_add_u32 v28, 0xffff4000, v28
    v_mfma_f32_16x16x32_bf16 v[136:139], v[4:7], a[144:147], v[136:139]
    ds_read_b64_tr_b16 v[196:197], v29 offset:0
    ds_read_b64_tr_b16 v[198:199], v29 offset:2048
    buffer_load_dword v2, v3, s[20:23], s39 offen offset:0
    v_mfma_f32_16x16x32_bf16 v[156:159], v[6:9], a[148:151], v[156:159]
    s_add_u32 s39, s39, 0x10000
    v_add_u32 v29, 0xffff4000, v29
    v_cvt_pk_bf16_f32 v188, v188, v189
    v_cvt_pk_bf16_f32 v189, v190, v191
    v_mfma_f32_16x16x32_bf16 v[36:39], v[4:7], a[148:151], v[36:39]
    s_add_u32 m0, s37, 0x1c000
    v_cvt_pk_bf16_f32 v190, v208, v209
    v_cvt_pk_bf16_f32 v191, v210, v211
    v_mfma_f32_16x16x32_bf16 a[164:167], a[180:183], v[80:83], a[164:167]
    s_xor_b32 s38, s34, 0x30200
    ds_write_b128 v27, v[188:191] offset:3072
    v_cvt_pk_bf16_f32 v228, v228, v229
    v_cvt_pk_bf16_f32 v229, v230, v231
    v_mfma_f32_16x16x32_bf16 a[168:171], a[180:183], v[84:87], a[168:171]
    v_cvt_pk_bf16_f32 v230, v248, v249
    v_cvt_pk_bf16_f32 v231, v250, v251
    v_mfma_f32_16x16x32_bf16 a[172:175], a[180:183], v[88:91], a[172:175]
    v_mul_f32 v116, v116, v70
    v_mul_f32 v117, v117, v70
    v_mul_f32 v118, v118, v70
    v_mul_f32 v119, v119, v70
    v_mul_f32 v136, v136, v70
    v_mfma_f32_16x16x32_bf16 a[176:179], a[180:183], v[92:95], a[176:179]
    buffer_load_dwordx4 v10, s[20:23], s38 offen offset:0 lds
    v_mul_f32 v137, v137, v70
    v_mul_f32 v138, v138, v70
    v_mul_f32 v139, v139, v70
    v_cvt_pk_bf16_f32 v116, v116, v117
    v_mfma_f32_16x16x32_bf16 v[120:123], a[128:131], v[80:83], v[120:123]
    ds_write_b128 v27, v[228:231] offset:23552
    v_cvt_pk_bf16_f32 v117, v118, v119
    v_cvt_pk_bf16_f32 v118, v136, v137
    v_cvt_pk_bf16_f32 v119, v138, v139
    v_mfma_f32_16x16x32_bf16 v[140:143], a[132:135], v[80:83], v[140:143]
    ds_write_b128 v26, v[116:119] offset:0
    v_mul_f32 v156, v156, v70
    v_accvgpr_read_b32 v57, a164
    v_mul_f32 v157, v157, v70
    v_mul_f32 v158, v158, v70
    v_mfma_f32_16x16x32_bf16 v[160:163], a[136:139], v[80:83], v[160:163]
    v_accvgpr_read_b32 v58, a168
    v_mul_f32 v159, v159, v70
    v_mul_f32 v36, v36, v70
    v_mul_f32 v37, v37, v70
    v_mul_f32 v38, v38, v70
    v_mul_f32 v39, v39, v70
    v_mfma_f32_16x16x32_bf16 v[40:43], a[140:143], v[80:83], v[40:43]
    buffer_load_dwordx4 v11, s[20:23], s38 offen offset:1024 lds
    v_accvgpr_read_b32 v59, a172
    v_cvt_pk_bf16_f32 v156, v156, v157
    v_cvt_pk_bf16_f32 v157, v158, v159
    v_cvt_pk_bf16_f32 v158, v36, v37
    v_mfma_f32_16x16x32_bf16 v[124:127], a[128:131], v[84:87], v[124:127]
    v_accvgpr_read_b32 v60, a176
    v_max3_f32 v62, v56, v57, v58
    v_min3_f32 v63, v56, v57, v58
    v_max3_f32 v62, v62, v59, v60
    v_min3_f32 v63, v63, v59, v60
    v_cmp_lt_f32 s[66:67], s45, v62
    v_cmp_gt_f32 s[40:41], s46, v63
    v_mfma_f32_16x16x32_bf16 v[144:147], a[132:135], v[84:87], v[144:147]
    s_waitcnt vmcnt(6)
    ds_write2_b32 v1, v57, v58 offset0:16 offset1:32
    ds_read_b64_tr_b16 v[180:181], v28 offset:0
    v_cvt_pk_bf16_f32 v159, v38, v39
    ds_write_b128 v26, v[156:159] offset:20480
    v_mfma_f32_16x16x32_bf16 v[164:167], a[136:139], v[84:87], v[164:167]
    ds_write2_b32 v1, v59, v60 offset0:48 offset1:64
    s_or_b64 s[66:67], s[66:67], s[40:41]
    s_cselect_b32 s45, 1, 0
    buffer_load_dwordx4 v12, s[20:23], s38 offen offset:2048 lds
    v_mov_b32 v61, s45
    ds_write_b32 v1, v61 offset:320
    v_mfma_f32_16x16x32_bf16 v[44:47], a[140:143], v[84:87], v[44:47]
    ds_read_b64_tr_b16 v[182:183], v28 offset:2048
    v_add_u32 v28, 0x10000, v28
    v_mfma_f32_16x16x32_bf16 v[128:131], a[128:131], v[88:91], v[128:131]
    s_waitcnt lgkmcnt(1)
    s_barrier
    ds_read_b64_tr_b16 v[200:201], v29 offset:0
    ds_read_b64_tr_b16 v[202:203], v29 offset:2048
    ds_read_b128 a[152:155], v26 offset:1024
    v_mfma_f32_16x16x32_bf16 v[148:151], a[132:135], v[88:91], v[148:151]
L_hop4:
    s_cbranch_execz L_hop5
    ds_read_b128 a[156:159], v26 offset:21504
    ds_read_b128 a[160:163], v26 offset:2048
    v_mfma_f32_16x16x32_bf16 v[168:171], a[136:139], v[88:91], v[168:171]
    buffer_load_dwordx4 v13, s[20:23], s38 offen offset:3072 lds
    ds_read_b128 a[164:167], v26 offset:22528
    v_mfma_f32_16x16x32_bf16 v[48:51], a[140:143], v[88:91], v[48:51]
    s_add_u32 m0, s37, 0x24000
    s_xor_b32 s38, s34, 0x38200
    v_add_u32 v29, 0x10000, v29
    v_mfma_f32_16x16x32_bf16 v[132:135], a[128:131], v[92:95], v[132:135]
    buffer_load_dwordx4 v10, s[20:23], s38 offen offset:0 lds
    ds_read_b64_tr_b16 v[216:217], v30 offset:0
    v_mfma_f32_16x16x32_bf16 v[152:155], a[132:135], v[92:95], v[152:155]
    ds_read_b128 a[80:83], v14 offset:5120
    ds_read_b64_tr_b16 v[218:219], v30 offset:2048
    ds_read_b128 a[84:87], v14 offset:25600
    v_mfma_f32_16x16x32_bf16 v[172:175], a[136:139], v[92:95], v[172:175]
    ds_read_b128 a[88:91], v14 offset:0
    ds_read_b128 a[92:95], v14 offset:20480
    v_add_u32 v30, 0xffff4000, v30
    v_mfma_f32_16x16x32_bf16 v[52:55], a[140:143], v[92:95], v[52:55]
    s_waitcnt lgkmcnt(9)
    ds_read_b64_tr_b16 v[236:237], v31 offset:0
    ds_read_b64_tr_b16 v[238:239], v31 offset:2048
    ds_read_b128 a[96:99], v14 offset:15360
    v_mfma_f32_16x16x32_bf16 v[120:123], v[6:9], a[152:155], v[120:123]
    ds_read_b128 a[100:103], v14 offset:35840
    ds_read_b128 a[104:107], v14 offset:10240
    ds_read_b128 a[108:111], v14 offset:30720
    v_mfma_f32_16x16x32_bf16 v[140:143], v[4:7], a[152:155], v[140:143]
    s_waitcnt lgkmcnt(14)
    buffer_load_dwordx4 v11, s[20:23], s38 offen offset:1024 lds
    ds_read2_b32 v[64:65], v16 offset0:16 offset1:32
    v_mfma_f32_16x16x32_bf16 v[160:163], v[6:9], a[156:159], v[160:163]
    ds_read2_b32 v[66:67], v16 offset0:48 offset1:64
    ds_read_b32 v69, v33 offset:320
    v_add_u32 v31, 0xffff4000, v31
    v_mfma_f32_16x16x32_bf16 v[40:43], v[4:7], a[156:159], v[40:43]
    s_waitcnt lgkmcnt(15)
    buffer_load_dwordx4 v12, s[20:23], s38 offen offset:2048 lds
    v_mfma_f32_16x16x32_bf16 v[124:127], v[6:9], a[160:163], v[124:127]
    v_cvt_pk_bf16_f32 v192, v192, v193
    v_cvt_pk_bf16_f32 v193, v194, v195
    v_mfma_f32_16x16x32_bf16 v[144:147], v[4:7], a[160:163], v[144:147]
    s_waitcnt lgkmcnt(1)
    v_add_f32 v57, v57, v64
    v_add_f32 v58, v58, v65
    v_add_f32 v59, v59, v66
    v_mfma_f32_16x16x32_bf16 v[164:167], v[6:9], a[164:167], v[164:167]
    v_add_f32 v60, v60, v67
    v_cvt_pk_bf16_f32 v194, v212, v213
    v_cvt_pk_bf16_f32 v195, v214, v215
    v_mfma_f32_16x16x32_bf16 v[44:47], v[4:7], a[164:167], v[44:47]
    buffer_load_dwordx4 v13, s[20:23], s38 offen offset:3072 lds
    s_add_u32 m0, s37, 0x10000
    v_mfma_f32_16x16x32_bf16 v[76:79], a[0:3], a[80:83], 0
    s_xor_b32 s38, s34, 0x200
    s_waitcnt lgkmcnt(0)
    v_cmp_lt_u32 s[66:67], s79, v69
    v_rcp_f32 v71, v57
    v_mfma_f32_16x16x32_bf16 v[76:79], a[16:19], a[84:87], v[76:79]
    ds_read_b64_tr_b16 v[220:221], v30 offset:0
    ds_read_b64_tr_b16 v[222:223], v30 offset:2048
    v_mul_f32 v120, v120, v71
    v_mfma_f32_16x16x32_bf16 v[76:79], a[32:35], a[88:91], v[76:79]
    buffer_load_dwordx4 v10, s[20:23], s38 offen offset:0 lds
    v_mul_f32 v121, v121, v71
    v_mfma_f32_16x16x32_bf16 v[76:79], a[48:51], a[92:95], v[76:79]
    v_add_u32 v30, 0x10000, v30
    v_mul_f32 v122, v122, v71
    v_mul_f32 v123, v123, v71
    v_mfma_f32_16x16x32_bf16 v[76:79], a[64:67], a[96:99], v[76:79]
    ds_read_b64_tr_b16 v[240:241], v31 offset:0
    ds_read_b64_tr_b16 v[242:243], v31 offset:2048
    v_mul_f32 v140, v140, v71
    v_mfma_f32_16x16x32_bf16 v[76:79], a[240:243], a[100:103], v[76:79]
    v_mul_f32 v141, v141, v71
    v_mul_f32 v142, v142, v71
    v_mul_f32 v143, v143, v71
    v_mfma_f32_16x16x32_bf16 v[76:79], v[176:179], a[104:107], v[76:79]
    buffer_load_dwordx4 v11, s[20:23], s38 offen offset:1024 lds
    v_cvt_pk_bf16_f32 v120, v120, v121
    v_mfma_f32_16x16x32_bf16 v[76:79], v[180:183], a[108:111], v[76:79]
    v_cvt_pk_bf16_f32 v121, v122, v123
    v_cvt_pk_bf16_f32 v122, v140, v141
    v_cvt_pk_bf16_f32 v123, v142, v143
    v_mfma_f32_16x16x32_bf16 v[80:83], a[4:7], a[80:83], 0
    s_cmp_lg_u64 s[66:67], 0
    s_cbranch_scc1 L_slow
    v_rcp_f32 v72, v58
    v_mfma_f32_16x16x32_bf16 v[80:83], a[20:23], a[84:87], v[80:83]
    buffer_load_dwordx4 v12, s[20:23], s38 offen offset:2048 lds
    v_add_u32 v31, 0x10000, v31
    v_mfma_f32_16x16x32_bf16 v[80:83], a[36:39], a[88:91], v[80:83]
    ds_write_b128 v26, v[120:123] offset:1024
    v_mul_f32 v160, v160, v71
    v_mul_f32 v161, v161, v71
    v_mfma_f32_16x16x32_bf16 v[80:83], a[52:55], a[92:95], v[80:83]
    v_rcp_f32 v73, v59
    v_mul_f32 v162, v162, v71
    v_mfma_f32_16x16x32_bf16 v[80:83], a[68:71], a[96:99], v[80:83]
    v_rcp_f32 v74, v60
    v_mul_f32 v163, v163, v71
    v_mfma_f32_16x16x32_bf16 v[80:83], a[244:247], a[100:103], v[80:83]
    v_mul_f32 v40, v40, v71
    v_mul_f32 v41, v41, v71
    v_mul_f32 v42, v42, v71
    v_mfma_f32_16x16x32_bf16 v[80:83], v[196:199], a[104:107], v[80:83]
    buffer_load_dwordx4 v13, s[20:23], s38 offen offset:3072 lds
    s_add_u32 m0, s37, 0x14000
    v_mfma_f32_16x16x32_bf16 v[80:83], v[200:203], a[108:111], v[80:83]
    s_xor_b32 s38, s34, 0x8200
    ds_write_b128 v27, v[192:195] offset:4096
    v_mul_f32 v43, v43, v71
    v_cvt_pk_bf16_f32 v160, v160, v161
    v_mfma_f32_16x16x32_bf16 v[84:87], a[8:11], a[80:83], 0
    v_cvt_pk_bf16_f32 v232, v232, v233
    v_cvt_pk_bf16_f32 v233, v234, v235
    v_cvt_pk_bf16_f32 v161, v162, v163
    v_mfma_f32_16x16x32_bf16 v[84:87], a[24:27], a[84:87], v[84:87]
    buffer_load_dwordx4 v10, s[20:23], s38 offen offset:0 lds
    v_cvt_pk_bf16_f32 v162, v40, v41
    v_mfma_f32_16x16x32_bf16 v[84:87], a[40:43], a[88:91], v[84:87]
    v_cvt_pk_bf16_f32 v234, v252, v253
    v_cvt_pk_bf16_f32 v235, v254, v255
    v_cvt_pk_bf16_f32 v163, v42, v43
    v_mfma_f32_16x16x32_bf16 v[84:87], a[56:59], a[92:95], v[84:87]
    ds_write_b128 v27, v[232:235] offset:24576
    ds_write_b128 v26, v[160:163] offset:21504
    v_mfma_f32_16x16x32_bf16 v[84:87], a[72:75], a[96:99], v[84:87]
    buffer_load_dwordx4 v11, s[20:23], s38 offen offset:1024 lds
    v_mfma_f32_16x16x32_bf16 v[84:87], a[248:251], a[100:103], v[84:87]
    v_cvt_pk_bf16_f32 v76, v76, v77
    v_cvt_pk_bf16_f32 v77, v78, v79
    s_mov_b32 s39, 0x0
    v_mfma_f32_16x16x32_bf16 v[84:87], v[216:219], a[104:107], v[84:87]
    s_waitcnt lgkmcnt(0)
    s_barrier
    ds_read_b128 a[208:211], v26 offset:3072
    ds_read_b128 a[212:215], v26 offset:23552
    ds_read_b128 a[216:219], v26 offset:4096
    v_mfma_f32_16x16x32_bf16 v[84:87], v[220:223], a[108:111], v[84:87]
    v_cvt_pk_bf16_f32 v78, v80, v81
    v_cvt_pk_bf16_f32 v79, v82, v83
    v_mfma_f32_16x16x32_bf16 v[88:91], a[12:15], a[80:83], 0
    buffer_load_dwordx4 v12, s[20:23], s38 offen offset:2048 lds
    ds_read_b128 a[220:223], v26 offset:24576
    v_mfma_f32_16x16x32_bf16 v[88:91], a[28:31], a[84:87], v[88:91]
    buffer_store_dwordx4 v[76:79], v34, s[24:27], s39 offen offset:0 sc1
    v_mfma_f32_16x16x32_bf16 v[88:91], a[44:47], a[88:91], v[88:91]
    ds_read_b128 a[112:115], v14 offset:6144
    ds_read_b128 a[116:119], v14 offset:26624
    ds_read_b128 a[120:123], v14 offset:1024
    v_mfma_f32_16x16x32_bf16 v[88:91], a[60:63], a[92:95], v[88:91]
    buffer_load_dwordx4 v13, s[20:23], s38 offen offset:3072 lds
    v_mfma_f32_16x16x32_bf16 v[88:91], a[76:79], a[96:99], v[88:91]
    s_add_u32 m0, s37, 0x20000
    s_xor_b32 s38, s34, 0x10200
    v_mfma_f32_16x16x32_bf16 v[88:91], a[252:255], a[100:103], v[88:91]
    ds_read_b128 a[124:127], v14 offset:21504
    ds_read_b128 a[128:131], v14 offset:16384
    v_mfma_f32_16x16x32_bf16 v[88:91], v[236:239], a[104:107], v[88:91]
    s_waitcnt vmcnt(13)
    buffer_load_dwordx4 v10, s[20:23], s38 offen offset:0 lds
    v_mfma_f32_16x16x32_bf16 v[88:91], v[240:243], a[108:111], v[88:91]
    s_waitcnt lgkmcnt(8)
    ds_read_b128 a[132:135], v14 offset:36864
    ds_read_b128 a[136:139], v14 offset:11264
    ds_read_b128 a[140:143], v14 offset:31744
    v_mfma_f32_16x16x32_bf16 v[128:131], v[6:9], a[208:211], v[128:131]
    ds_read_b64_tr_b16 v[184:185], v28 offset:0
    ds_read_b64_tr_b16 v[186:187], v28 offset:2048
    v_mfma_f32_16x16x32_bf16 v[148:151], v[4:7], a[208:211], v[148:151]
    s_waitcnt lgkmcnt(12)
    ds_read_b64_tr_b16 v[204:205], v29 offset:0
    ds_read_b64_tr_b16 v[206:207], v29 offset:2048
    v_mfma_f32_16x16x32_bf16 v[168:171], v[6:9], a[212:215], v[168:171]
    buffer_load_dwordx4 v11, s[20:23], s38 offen offset:1024 lds
    ds_read_b64_tr_b16 v[224:225], v30 offset:0
    v_mfma_f32_16x16x32_bf16 v[48:51], v[4:7], a[212:215], v[48:51]
    s_waitcnt lgkmcnt(14)
    ds_read_b64_tr_b16 v[226:227], v30 offset:2048
    ds_read_b64_tr_b16 v[244:245], v31 offset:0
    v_mfma_f32_16x16x32_bf16 v[132:135], v[6:9], a[216:219], v[132:135]
    v_cvt_pk_bf16_f32 v84, v84, v85
    v_cvt_pk_bf16_f32 v85, v86, v87
    v_mfma_f32_16x16x32_bf16 v[152:155], v[4:7], a[216:219], v[152:155]
    s_waitcnt lgkmcnt(15)
    s_mov_b32 s39, 0x28000
    ds_read_b64_tr_b16 v[246:247], v31 offset:2048
    v_mul_f32 v124, v124, v72
    v_mfma_f32_16x16x32_bf16 v[172:175], v[6:9], a[220:223], v[172:175]
    buffer_load_dwordx4 v12, s[20:23], s38 offen offset:2048 lds
    v_mfma_f32_16x16x32_bf16 v[52:55], v[4:7], a[220:223], v[52:55]
    s_waitcnt lgkmcnt(8)
    v_cvt_pk_bf16_f32 v86, v88, v89
    v_cvt_pk_bf16_f32 v87, v90, v91
    v_mul_f32 v125, v125, v72
    v_mfma_f32_16x16x32_bf16 v[116:119], a[0:3], a[112:115], 0
    v_mul_f32 v126, v126, v72
    v_mul_f32 v127, v127, v72
    v_mfma_f32_16x16x32_bf16 v[116:119], a[16:19], a[116:119], v[116:119]
    buffer_load_dwordx4 v13, s[20:23], s38 offen offset:3072 lds
    v_mfma_f32_16x16x32_bf16 v[116:119], a[32:35], a[120:123], v[116:119]
    buffer_store_dwordx4 v[84:87], v34, s[24:27], s39 offen offset:0 sc1
    v_mul_f32 v144, v144, v72
    v_mfma_f32_16x16x32_bf16 v[116:119], a[48:51], a[124:127], v[116:119]
    s_add_u32 m0, s37, 0x18000
    s_xor_b32 s38, s34, 0x18200
    v_mul_f32 v145, v145, v72
    v_mfma_f32_16x16x32_bf16 v[116:119], a[64:67], a[128:131], v[116:119]
    v_mul_f32 v146, v146, v72
    v_mul_f32 v147, v147, v72
    v_mfma_f32_16x16x32_bf16 v[116:119], a[240:243], a[132:135], v[116:119]
    buffer_load_dwordx4 v10, s[20:23], s38 offen offset:0 lds
    v_mfma_f32_16x16x32_bf16 v[116:119], v[176:179], a[136:139], v[116:119]
    v_cvt_pk_bf16_f32 v124, v124, v125
    v_cvt_pk_bf16_f32 v125, v126, v127
    v_cvt_pk_bf16_f32 v126, v144, v145
    v_mfma_f32_16x16x32_bf16 v[116:119], v[180:183], a[140:143], v[116:119]
    v_cvt_pk_bf16_f32 v127, v146, v147
    v_mfma_f32_16x16x32_bf16 v[136:139], a[4:7], a[112:115], 0
    ds_write_b128 v26, v[124:127] offset:2048
    v_mfma_f32_16x16x32_bf16 v[136:139], a[20:23], a[116:119], v[136:139]
    buffer_load_dwordx4 v11, s[20:23], s38 offen offset:1024 lds
    v_mul_f32 v164, v164, v72
    v_mfma_f32_16x16x32_bf16 v[136:139], a[36:39], a[120:123], v[136:139]
    v_mul_f32 v165, v165, v72
    v_mul_f32 v166, v166, v72
    v_mfma_f32_16x16x32_bf16 v[136:139], a[52:55], a[124:127], v[136:139]
    v_mul_f32 v167, v167, v72
    v_mul_f32 v44, v44, v72
    v_mul_f32 v45, v45, v72
    v_mfma_f32_16x16x32_bf16 v[136:139], a[68:71], a[128:131], v[136:139]
    buffer_load_dwordx4 v12, s[20:23], s38 offen offset:2048 lds
    v_mfma_f32_16x16x32_bf16 v[136:139], a[244:247], a[132:135], v[136:139]
    v_mul_f32 v46, v46, v72
    v_mul_f32 v47, v47, v72
    v_cvt_pk_bf16_f32 v164, v164, v165
    v_mfma_f32_16x16x32_bf16 v[136:139], v[196:199], a[136:139], v[136:139]
    v_cvt_pk_bf16_f32 v165, v166, v167
    v_cvt_pk_bf16_f32 v166, v44, v45
    v_mfma_f32_16x16x32_bf16 v[136:139], v[200:203], a[140:143], v[136:139]
    buffer_load_dwordx4 v13, s[20:23], s38 offen offset:3072 lds
    v_cvt_pk_bf16_f32 v167, v46, v47
    v_mfma_f32_16x16x32_bf16 v[156:159], a[8:11], a[112:115], 0
    ds_write_b128 v26, v[164:167] offset:22528
    v_mfma_f32_16x16x32_bf16 v[156:159], a[24:27], a[116:119], v[156:159]
    s_add_u32 m0, s37, 0xc000
    s_xor_b32 s38, s34, 0x20200
    v_mul_f32 v128, v128, v73
    v_mfma_f32_16x16x32_bf16 v[156:159], a[40:43], a[120:123], v[156:159]
    buffer_load_dwordx4 v10, s[20:23], s38 offen offset:0 lds
    v_mfma_f32_16x16x32_bf16 v[156:159], a[56:59], a[124:127], v[156:159]
    s_waitcnt lgkmcnt(0)
    s_barrier
    v_cvt_pk_bf16_f32 v116, v116, v117
    v_cvt_pk_bf16_f32 v117, v118, v119
    v_mfma_f32_16x16x32_bf16 v[156:159], a[72:75], a[128:131], v[156:159]
    s_mov_b32 s39, 0x8000
    ds_read_b128 a[144:147], v14 offset:7168
    ds_read_b128 a[148:151], v14 offset:27648
    v_mfma_f32_16x16x32_bf16 v[156:159], a[248:251], a[132:135], v[156:159]
    ds_read_b128 a[152:155], v14 offset:2048
    ds_read_b128 a[156:159], v14 offset:22528
    ds_read_b128 a[160:163], v14 offset:17408
    v_mfma_f32_16x16x32_bf16 v[156:159], v[216:219], a[136:139], v[156:159]
    buffer_load_dwordx4 v11, s[20:23], s38 offen offset:1024 lds
    v_mfma_f32_16x16x32_bf16 v[156:159], v[220:223], a[140:143], v[156:159]
    v_cvt_pk_bf16_f32 v118, v136, v137
    v_cvt_pk_bf16_f32 v119, v138, v139
    v_mfma_f32_16x16x32_bf16 v[36:39], a[12:15], a[112:115], 0
    ds_read_b128 a[164:167], v14 offset:37888
    ds_read_b128 a[168:171], v14 offset:12288
    v_mfma_f32_16x16x32_bf16 v[36:39], a[28:31], a[116:119], v[36:39]
    ds_read_b128 a[172:175], v14 offset:32768
    buffer_load_dwordx4 v12, s[20:23], s38 offen offset:2048 lds
    v_mfma_f32_16x16x32_bf16 v[36:39], a[44:47], a[120:123], v[36:39]
    buffer_store_dwordx4 v[116:119], v34, s[24:27], s39 offen offset:0 sc1
    v_mfma_f32_16x16x32_bf16 v[36:39], a[60:63], a[124:127], v[36:39]
    v_mul_f32 v129, v129, v73
    v_mul_f32 v130, v130, v73
    v_mfma_f32_16x16x32_bf16 v[36:39], a[76:79], a[128:131], v[36:39]
    v_mul_f32 v131, v131, v73
    v_mul_f32 v148, v148, v73
    v_mfma_f32_16x16x32_bf16 v[36:39], a[252:255], a[132:135], v[36:39]
    buffer_load_dwordx4 v13, s[20:23], s38 offen offset:3072 lds
    v_mfma_f32_16x16x32_bf16 v[36:39], v[236:239], a[136:139], v[36:39]
    s_add_u32 m0, s37, 0x1c000
    s_xor_b32 s38, s34, 0x28200
    v_mfma_f32_16x16x32_bf16 v[36:39], v[240:243], a[140:143], v[36:39]
    s_waitcnt lgkmcnt(0)
    v_mul_f32 v149, v149, v73
    v_mul_f32 v150, v150, v73
    v_mfma_f32_16x16x32_bf16 v[76:79], a[0:3], a[144:147], 0
    buffer_load_dwordx4 v10, s[20:23], s38 offen offset:0 lds
    v_mfma_f32_16x16x32_bf16 v[76:79], a[16:19], a[148:151], v[76:79]
    v_mul_f32 v151, v151, v73
    v_cvt_pk_bf16_f32 v128, v128, v129
    v_mfma_f32_16x16x32_bf16 v[76:79], a[32:35], a[152:155], v[76:79]
    v_cvt_pk_bf16_f32 v129, v130, v131
    v_cvt_pk_bf16_f32 v130, v148, v149
    v_mfma_f32_16x16x32_bf16 v[76:79], a[48:51], a[156:159], v[76:79]
    v_cvt_pk_bf16_f32 v156, v156, v157
    v_cvt_pk_bf16_f32 v157, v158, v159
    v_mfma_f32_16x16x32_bf16 v[76:79], a[64:67], a[160:163], v[76:79]
    s_mov_b32 s39, 0x30000
    buffer_load_dwordx4 v11, s[20:23], s38 offen offset:1024 lds
    v_mfma_f32_16x16x32_bf16 v[76:79], a[240:243], a[164:167], v[76:79]
    v_cvt_pk_bf16_f32 v131, v150, v151
    v_mfma_f32_16x16x32_bf16 v[76:79], v[176:179], a[168:171], v[76:79]
    v_cvt_pk_bf16_f32 v158, v36, v37
    v_cvt_pk_bf16_f32 v159, v38, v39
    v_mfma_f32_16x16x32_bf16 v[76:79], v[180:183], a[172:175], v[76:79]
    ds_write_b128 v26, v[128:131] offset:3072
    v_mfma_f32_16x16x32_bf16 v[80:83], a[4:7], a[144:147], 0
    buffer_load_dwordx4 v12, s[20:23], s38 offen offset:2048 lds
    v_mul_f32 v168, v168, v73
    v_mfma_f32_16x16x32_bf16 v[80:83], a[20:23], a[148:151], v[80:83]
    v_mul_f32 v169, v169, v73
    v_mul_f32 v170, v170, v73
    v_mfma_f32_16x16x32_bf16 v[80:83], a[36:39], a[152:155], v[80:83]
    buffer_store_dwordx4 v[156:159], v34, s[24:27], s39 offen offset:0 sc1
    v_mfma_f32_16x16x32_bf16 v[80:83], a[52:55], a[156:159], v[80:83]
    v_mul_f32 v171, v171, v73
    v_mul_f32 v48, v48, v73
    v_mfma_f32_16x16x32_bf16 v[80:83], a[68:71], a[160:163], v[80:83]
    buffer_load_dwordx4 v13, s[20:23], s38 offen offset:3072 lds
    v_mfma_f32_16x16x32_bf16 v[80:83], a[244:247], a[164:167], v[80:83]
    v_mul_f32 v49, v49, v73
    v_mul_f32 v50, v50, v73
    v_mfma_f32_16x16x32_bf16 v[80:83], v[196:199], a[168:171], v[80:83]
    v_mul_f32 v51, v51, v73
    v_cvt_pk_bf16_f32 v168, v168, v169
    v_cvt_pk_bf16_f32 v169, v170, v171
    v_mfma_f32_16x16x32_bf16 v[80:83], v[200:203], a[172:175], v[80:83]
    v_cvt_pk_bf16_f32 v170, v48, v49
    v_cvt_pk_bf16_f32 v171, v50, v51
    v_mfma_f32_16x16x32_bf16 v[84:87], a[8:11], a[144:147], 0
    ds_write_b128 v26, v[168:171] offset:23552
    v_mfma_f32_16x16x32_bf16 v[84:87], a[24:27], a[148:151], v[84:87]
    v_cvt_pk_bf16_f32 v76, v76, v77
    v_cvt_pk_bf16_f32 v77, v78, v79
    v_mfma_f32_16x16x32_bf16 v[84:87], a[40:43], a[152:155], v[84:87]
    s_mov_b32 s39, 0x10000
    v_mul_f32 v132, v132, v74
    v_mul_f32 v133, v133, v74
    v_mfma_f32_16x16x32_bf16 v[84:87], a[56:59], a[156:159], v[84:87]
    s_waitcnt lgkmcnt(0)
    s_barrier
    ds_read_b128 a[176:179], v14 offset:8192
    v_mfma_f32_16x16x32_bf16 v[84:87], a[72:75], a[160:163], v[84:87]
    ds_read_b128 a[180:183], v14 offset:28672
    ds_read_b128 a[184:187], v14 offset:3072
    v_mfma_f32_16x16x32_bf16 v[84:87], a[248:251], a[164:167], v[84:87]
    ds_read_b128 a[188:191], v14 offset:23552
    ds_read_b128 a[192:195], v14 offset:18432
    v_mfma_f32_16x16x32_bf16 v[84:87], v[216:219], a[168:171], v[84:87]
    v_cvt_pk_bf16_f32 v78, v80, v81
    v_cvt_pk_bf16_f32 v79, v82, v83
    v_mfma_f32_16x16x32_bf16 v[84:87], v[220:223], a[172:175], v[84:87]
    ds_read_b128 a[196:199], v14 offset:38912
    ds_read_b128 a[200:203], v14 offset:13312
    v_mfma_f32_16x16x32_bf16 v[88:91], a[12:15], a[144:147], 0
    ds_read_b128 a[204:207], v14 offset:33792
    v_mul_f32 v134, v134, v74
    v_mfma_f32_16x16x32_bf16 v[88:91], a[28:31], a[148:151], v[88:91]
    buffer_store_dwordx4 v[76:79], v34, s[24:27], s39 offen offset:0 sc1
    v_mfma_f32_16x16x32_bf16 v[88:91], a[44:47], a[152:155], v[88:91]
    v_mul_f32 v135, v135, v74
    v_mul_f32 v152, v152, v74
    v_mfma_f32_16x16x32_bf16 v[88:91], a[60:63], a[156:159], v[88:91]
    v_mul_f32 v153, v153, v74
    v_mul_f32 v154, v154, v74
    v_mfma_f32_16x16x32_bf16 v[88:91], a[76:79], a[160:163], v[88:91]
    s_waitcnt vmcnt(29)
    ds_read_b64_tr_b16 v[188:189], v28 offset:32768
    ds_read_b64_tr_b16 v[190:191], v28 offset:34816
    v_mfma_f32_16x16x32_bf16 v[88:91], a[252:255], a[164:167], v[88:91]
    v_add_u32 v28, 0xffff4000, v28
    v_mul_f32 v155, v155, v74
    v_mfma_f32_16x16x32_bf16 v[88:91], v[236:239], a[168:171], v[88:91]
    ds_read_b64_tr_b16 v[208:209], v29 offset:32768
    ds_read_b64_tr_b16 v[210:211], v29 offset:34816
    v_mfma_f32_16x16x32_bf16 v[88:91], v[240:243], a[172:175], v[88:91]
    s_waitcnt lgkmcnt(4)
    v_add_u32 v29, 0xffff4000, v29
    v_cvt_pk_bf16_f32 v132, v132, v133
    v_mfma_f32_16x16x32_bf16 v[116:119], a[0:3], a[176:179], 0
    ds_read_b64_tr_b16 v[228:229], v30 offset:32768
    ds_read_b64_tr_b16 v[230:231], v30 offset:34816
    v_mfma_f32_16x16x32_bf16 v[116:119], a[16:19], a[180:183], v[116:119]
    v_add_u32 v30, 0xffff4000, v30
    v_cvt_pk_bf16_f32 v133, v134, v135
    v_mfma_f32_16x16x32_bf16 v[116:119], a[32:35], a[184:187], v[116:119]
    ds_read_b64_tr_b16 v[248:249], v31 offset:32768
    ds_read_b64_tr_b16 v[250:251], v31 offset:34816
    v_mfma_f32_16x16x32_bf16 v[116:119], a[48:51], a[188:191], v[116:119]
    v_cvt_pk_bf16_f32 v134, v152, v153
    v_cvt_pk_bf16_f32 v135, v154, v155
    v_mfma_f32_16x16x32_bf16 v[116:119], a[64:67], a[192:195], v[116:119]
    v_cvt_pk_bf16_f32 v84, v84, v85
    v_cvt_pk_bf16_f32 v85, v86, v87
    v_mfma_f32_16x16x32_bf16 v[116:119], a[240:243], a[196:199], v[116:119]
    s_mov_b32 s39, 0x38000
    ds_write_b128 v26, v[132:135] offset:4096
    v_mfma_f32_16x16x32_bf16 v[116:119], v[176:179], a[200:203], v[116:119]
    v_cvt_pk_bf16_f32 v86, v88, v89
    v_cvt_pk_bf16_f32 v87, v90, v91
    v_mfma_f32_16x16x32_bf16 v[116:119], v[180:183], a[204:207], v[116:119]
    v_mul_f32 v172, v172, v74
    v_mul_f32 v173, v173, v74
    v_mfma_f32_16x16x32_bf16 v[136:139], a[4:7], a[176:179], 0
    v_mul_f32 v174, v174, v74
    v_mul_f32 v175, v175, v74
    v_mfma_f32_16x16x32_bf16 v[136:139], a[20:23], a[180:183], v[136:139]
    buffer_store_dwordx4 v[84:87], v34, s[24:27], s39 offen offset:0 sc1
    v_mfma_f32_16x16x32_bf16 v[136:139], a[36:39], a[184:187], v[136:139]
    v_mul_f32 v52, v52, v74
    v_mul_f32 v53, v53, v74
    v_mfma_f32_16x16x32_bf16 v[136:139], a[52:55], a[188:191], v[136:139]
    v_mul_f32 v54, v54, v74
    v_mul_f32 v55, v55, v74
    v_mfma_f32_16x16x32_bf16 v[136:139], a[68:71], a[192:195], v[136:139]
    v_cvt_pk_bf16_f32 v172, v172, v173
    v_cvt_pk_bf16_f32 v173, v174, v175
    v_mfma_f32_16x16x32_bf16 v[136:139], a[244:247], a[196:199], v[136:139]
    v_cvt_pk_bf16_f32 v174, v52, v53
    v_cvt_pk_bf16_f32 v175, v54, v55
    v_mfma_f32_16x16x32_bf16 v[136:139], v[196:199], a[200:203], v[136:139]
    ds_write_b128 v26, v[172:175] offset:24576
    v_mfma_f32_16x16x32_bf16 v[136:139], v[200:203], a[204:207], v[136:139]
    v_cvt_pk_bf16_f32 v116, v116, v117
    v_cvt_pk_bf16_f32 v117, v118, v119
    v_mfma_f32_16x16x32_bf16 v[156:159], a[8:11], a[176:179], 0
    s_mov_b32 s39, 0x18000
    v_add_u32 v31, 0xffff4000, v31
    v_mfma_f32_16x16x32_bf16 v[156:159], a[24:27], a[180:183], v[156:159]
    v_mfma_f32_16x16x32_bf16 v[156:159], a[40:43], a[184:187], v[156:159]
    v_mfma_f32_16x16x32_bf16 v[156:159], a[56:59], a[188:191], v[156:159]
    s_waitcnt lgkmcnt(0)
    s_barrier
    ds_read_b128 a[208:211], v14 offset:9216
    v_mfma_f32_16x16x32_bf16 v[156:159], a[72:75], a[192:195], v[156:159]
    s_lshl_b32 s43, s78, 7
    ds_read_b128 a[212:215], v14 offset:29696
    ds_read_b128 a[216:219], v14 offset:4096
    v_mfma_f32_16x16x32_bf16 v[156:159], a[248:251], a[196:199], v[156:159]
    s_add_u32 s43, s43, s80
    ds_read_b128 a[220:223], v14 offset:24576
    ds_read_b128 a[224:227], v14 offset:19456
    v_mfma_f32_16x16x32_bf16 v[156:159], v[216:219], a[200:203], v[156:159]
    s_add_u32 s43, s43, 0xa0080
    v_cvt_pk_bf16_f32 v118, v136, v137
    v_cvt_pk_bf16_f32 v119, v138, v139
    v_mfma_f32_16x16x32_bf16 v[156:159], v[220:223], a[204:207], v[156:159]
    ds_read_b128 a[228:231], v14 offset:39936
    ds_read_b128 a[232:235], v14 offset:14336
    v_mfma_f32_16x16x32_bf16 v[36:39], a[12:15], a[176:179], 0
    ds_read_b128 a[236:239], v14 offset:34816
    v_lshl_add_u32 v96, v0, 20, s43
    v_mfma_f32_16x16x32_bf16 v[36:39], a[28:31], a[180:183], v[36:39]
    s_mul_i32 s43, s77, 163840
    buffer_store_dwordx4 v[116:119], v34, s[24:27], s39 offen offset:0 sc1
    v_mfma_f32_16x16x32_bf16 v[36:39], a[44:47], a[184:187], v[36:39]
    s_lshl_b32 s44, s76, 10
    s_add_u32 s43, s43, s44
    v_mfma_f32_16x16x32_bf16 v[36:39], a[60:63], a[188:191], v[36:39]
    s_add_u32 s8, s68, s43
    s_addc_u32 s9, s69, 0
    s_sub_u32 s10, 163840, s44
    v_mfma_f32_16x16x32_bf16 v[36:39], a[76:79], a[192:195], v[36:39]
    v_lshl_add_u32 v98, v0, 4, s80
    v_and_b32 v101, 7, v0
    v_mfma_f32_16x16x32_bf16 v[36:39], a[252:255], a[196:199], v[36:39]
    s_lshl_b32 s43, s36, 7
    v_lshl_add_u32 v99, v101, 11, s43
    v_bfe_u32 v100, v0, 4, 1
    v_mfma_f32_16x16x32_bf16 v[36:39], v[236:239], a[200:203], v[36:39]
    v_cvt_pk_bf16_f32 v156, v156, v157
    v_cvt_pk_bf16_f32 v157, v158, v159
    v_mfma_f32_16x16x32_bf16 v[36:39], v[240:243], a[204:207], v[36:39]
    s_waitcnt lgkmcnt(0)
    s_mov_b32 s39, 0x40000
    v_lshl_add_u32 v99, v100, 5, v99
    v_mfma_f32_16x16x32_bf16 v[76:79], a[0:3], a[208:211], 0
    s_waitcnt vmcnt(27)
    ds_read_b64_tr_b16 a[0:1], v28 offset:0
    ds_read_b64_tr_b16 a[2:3], v28 offset:2048
    v_mfma_f32_16x16x32_bf16 v[76:79], a[16:19], a[212:215], v[76:79]
    s_waitcnt vmcnt(22)
    ds_read_b64_tr_b16 a[16:17], v28 offset:16384
    ds_read_b64_tr_b16 a[18:19], v28 offset:18432
    v_mfma_f32_16x16x32_bf16 v[76:79], a[32:35], a[216:219], v[76:79]
    v_add_u32 v28, 0x8000, v28
    s_waitcnt vmcnt(18)
    v_mfma_f32_16x16x32_bf16 v[76:79], a[48:51], a[220:223], v[76:79]
    ds_read_b64_tr_b16 a[32:33], v28 offset:32768
    ds_read_b64_tr_b16 a[34:35], v28 offset:34816
    v_mfma_f32_16x16x32_bf16 v[76:79], a[64:67], a[224:227], v[76:79]
    s_waitcnt vmcnt(13)
    ds_read_b64_tr_b16 a[48:49], v28 offset:0
    ds_read_b64_tr_b16 a[50:51], v28 offset:2048
    v_mfma_f32_16x16x32_bf16 v[76:79], a[240:243], a[228:231], v[76:79]
    v_add_u32 v28, 0xffff4000, v28
    s_waitcnt vmcnt(8)
    v_mfma_f32_16x16x32_bf16 v[76:79], v[176:179], a[232:235], v[76:79]
    v_cvt_pk_bf16_f32 v158, v36, v37
    v_cvt_pk_bf16_f32 v159, v38, v39
    v_mfma_f32_16x16x32_bf16 v[76:79], v[180:183], a[236:239], v[76:79]
    buffer_store_dwordx4 v[156:159], v34, s[24:27], s39 offen offset:0 sc1
    v_mfma_f32_16x16x32_bf16 v[80:83], a[4:7], a[208:211], 0
    ds_read_b64_tr_b16 a[64:65], v28 offset:0
    ds_read_b64_tr_b16 a[66:67], v28 offset:2048
    v_mfma_f32_16x16x32_bf16 v[80:83], a[20:23], a[212:215], v[80:83]
    v_add_u32 v28, 0x10000, v28
    s_waitcnt vmcnt(4)
    v_mfma_f32_16x16x32_bf16 v[80:83], a[36:39], a[216:219], v[80:83]
    ds_read_b64_tr_b16 a[240:241], v28 offset:0
    ds_read_b64_tr_b16 a[242:243], v28 offset:2048
    v_mfma_f32_16x16x32_bf16 v[80:83], a[52:55], a[220:223], v[80:83]
    ds_read_b64_tr_b16 a[4:5], v29 offset:0
    ds_read_b64_tr_b16 a[6:7], v29 offset:2048
    v_mfma_f32_16x16x32_bf16 v[80:83], a[68:71], a[224:227], v[80:83]
    ds_read_b64_tr_b16 a[20:21], v29 offset:16384
    ds_read_b64_tr_b16 a[22:23], v29 offset:18432
    v_mfma_f32_16x16x32_bf16 v[80:83], a[244:247], a[228:231], v[80:83]
    v_add_u32 v29, 0x8000, v29
    v_lshrrev_b32 v101, 5, v0
    v_mfma_f32_16x16x32_bf16 v[80:83], v[196:199], a[232:235], v[80:83]
    v_cvt_pk_bf16_f32 v76, v76, v77
    v_cvt_pk_bf16_f32 v77, v78, v79
    v_mfma_f32_16x16x32_bf16 v[80:83], v[200:203], a[236:239], v[80:83]
    s_mov_b32 s39, 0x20000
    ds_read_b64_tr_b16 a[36:37], v29 offset:32768
    ds_read_b64_tr_b16 a[38:39], v29 offset:34816
    v_mfma_f32_16x16x32_bf16 v[84:87], a[8:11], a[208:211], 0
    ds_read_b64_tr_b16 a[52:53], v29 offset:0
    ds_read_b64_tr_b16 a[54:55], v29 offset:2048
    v_mfma_f32_16x16x32_bf16 v[84:87], a[24:27], a[212:215], v[84:87]
    v_add_u32 v29, 0xffff4000, v29
    v_lshl_add_u32 v99, v101, 4, v99
    v_mfma_f32_16x16x32_bf16 v[84:87], a[40:43], a[216:219], v[84:87]
    ds_read_b64_tr_b16 a[68:69], v29 offset:0
    ds_read_b64_tr_b16 a[70:71], v29 offset:2048
    v_mfma_f32_16x16x32_bf16 v[84:87], a[56:59], a[220:223], v[84:87]
    v_add_u32 v29, 0x10000, v29
    v_bfe_u32 v101, v0, 3, 1
    v_mfma_f32_16x16x32_bf16 v[84:87], a[72:75], a[224:227], v[84:87]
    ds_read_b64_tr_b16 a[244:245], v29 offset:0
    ds_read_b64_tr_b16 a[246:247], v29 offset:2048
    v_mfma_f32_16x16x32_bf16 v[84:87], a[248:251], a[228:231], v[84:87]
    v_lshl_add_u32 v99, v101, 3, v99
    v_and_b32 v101, 15, v0
    v_mfma_f32_16x16x32_bf16 v[84:87], v[216:219], a[232:235], v[84:87]
    v_cvt_pk_bf16_f32 v78, v80, v81
    v_cvt_pk_bf16_f32 v79, v82, v83
    v_mfma_f32_16x16x32_bf16 v[84:87], v[220:223], a[236:239], v[84:87]
    buffer_store_dwordx4 v[76:79], v34, s[24:27], s39 offen offset:0 sc1
    v_mfma_f32_16x16x32_bf16 v[88:91], a[12:15], a[208:211], 0
    v_lshlrev_b32 v100, 3, v100
    v_sub_u32 v100, v101, v100
    v_mfma_f32_16x16x32_bf16 v[88:91], a[28:31], a[212:215], v[88:91]
    v_and_b32 v101, 1, v100
    v_lshlrev_b32 v101, 4, v101
    v_mfma_f32_16x16x32_bf16 v[88:91], a[44:47], a[216:219], v[88:91]
    s_mov_b32 s43, 0x3f80
    v_lshlrev_b32 v101, v101, s43
    v_ashrrev_i32 v100, 1, v100
    v_mfma_f32_16x16x32_bf16 v[88:91], a[60:63], a[220:223], v[88:91]
    v_cmp_eq_u32 s[66:67], 0, v100
    v_cmp_eq_u32 s[40:41], 1, v100
    v_mfma_f32_16x16x32_bf16 v[88:91], a[76:79], a[224:227], v[88:91]
L_hop5:
    s_cbranch_execz L_hop_ret
    s_lshl_b32 s46, s36, 2
    v_cndmask_b32 v104, 0, v101, s[66:67]
    v_cndmask_b32 v105, 0, v101, s[40:41]
    v_mfma_f32_16x16x32_bf16 v[88:91], a[252:255], a[228:231], v[88:91]
    v_cmp_eq_u32 s[66:67], 2, v100
    v_cmp_eq_u32 s[40:41], 3, v100
    v_mfma_f32_16x16x32_bf16 v[88:91], v[236:239], a[232:235], v[88:91]
    s_lshl_b32 s46, s36, 2
    v_cvt_pk_bf16_f32 v84, v84, v85
    v_cvt_pk_bf16_f32 v85, v86, v87
    v_mfma_f32_16x16x32_bf16 v[88:91], v[240:243], a[236:239], v[88:91]
    s_waitcnt lgkmcnt(15)
    s_mov_b32 s39, 0x48000
    v_cndmask_b32 v106, 0, v101, s[66:67]
    v_cndmask_b32 v107, 0, v101, s[40:41]
    v_mfma_f32_16x16x32_bf16 v[116:119], a[0:3], a[80:83], 0
    s_add_u32 s46, s46, s78
    s_mov_b32 s32, 0
    s_mov_b32 s33, 0
    s_waitcnt lgkmcnt(15)
    v_mfma_f32_16x16x32_bf16 v[116:119], a[16:19], a[84:87], v[116:119]
    s_waitcnt lgkmcnt(15)
    s_mov_b32 s34, 0
    s_mov_b32 s12, 0
    s_mov_b32 s13, 2048
    v_mfma_f32_16x16x32_bf16 v[116:119], a[32:35], a[88:91], v[116:119]
    s_waitcnt lgkmcnt(15)
    s_mov_b32 s14, 4096
    s_mov_b32 s15, 6144
    s_lshl_b32 s16, 1, s78
    v_mfma_f32_16x16x32_bf16 v[116:119], a[48:51], a[92:95], v[116:119]
    s_waitcnt lgkmcnt(14)
    s_xor_b32 s16, s16, 0xffff
    s_add_u32 s43, s80, 0xa0000
    v_lshl_add_u32 v103, v0, 20, s43
    v_mfma_f32_16x16x32_bf16 v[116:119], a[64:67], a[96:99], v[116:119]
    s_waitcnt lgkmcnt(12)
    v_mov_b32 v102, 1
    s_add_u32 s43, s80, 0xa0080
    v_mfma_f32_16x16x32_bf16 v[116:119], a[240:243], a[100:103], v[116:119]
    v_and_b32 v101, 15, v0
    v_lshl_add_u32 v101, v101, 7, s43
    v_mfma_f32_16x16x32_bf16 v[116:119], v[184:187], a[104:107], v[116:119]
    s_waitcnt lgkmcnt(0)
    v_cvt_pk_bf16_f32 v86, v88, v89
    v_cvt_pk_bf16_f32 v87, v90, v91
    v_mfma_f32_16x16x32_bf16 v[116:119], v[188:191], a[108:111], v[116:119]
    buffer_store_dwordx4 v[84:87], v34, s[24:27], s39 offen offset:0 sc1
    v_mfma_f32_16x16x32_bf16 v[136:139], a[4:7], a[80:83], 0
    ds_read_b64_tr_b16 a[8:9], v30 offset:0
    ds_read_b64_tr_b16 a[10:11], v30 offset:2048
    v_mfma_f32_16x16x32_bf16 v[136:139], a[20:23], a[84:87], v[136:139]
    ds_read_b64_tr_b16 a[24:25], v30 offset:16384
    ds_read_b64_tr_b16 a[26:27], v30 offset:18432
    v_mfma_f32_16x16x32_bf16 v[136:139], a[36:39], a[88:91], v[136:139]
    v_add_u32 v30, 0x8000, v30
    v_mfma_f32_16x16x32_bf16 v[136:139], a[52:55], a[92:95], v[136:139]
    ds_read_b64_tr_b16 a[40:41], v30 offset:32768
    ds_read_b64_tr_b16 a[42:43], v30 offset:34816
    v_mfma_f32_16x16x32_bf16 v[136:139], a[68:71], a[96:99], v[136:139]
    ds_read_b64_tr_b16 a[56:57], v30 offset:0
    ds_read_b64_tr_b16 a[58:59], v30 offset:2048
    v_mfma_f32_16x16x32_bf16 v[136:139], a[244:247], a[100:103], v[136:139]
    v_add_u32 v30, 0xffff4000, v30
    v_mfma_f32_16x16x32_bf16 v[136:139], v[204:207], a[104:107], v[136:139]
    v_cvt_pk_bf16_f32 v116, v116, v117
    v_cvt_pk_bf16_f32 v117, v118, v119
    v_mfma_f32_16x16x32_bf16 v[136:139], v[208:211], a[108:111], v[136:139]
    s_mov_b32 s39, 0x50000
    ds_read_b64_tr_b16 a[72:73], v30 offset:0
    ds_read_b64_tr_b16 a[74:75], v30 offset:2048
    v_mfma_f32_16x16x32_bf16 v[156:159], a[0:3], a[112:115], 0
    v_add_u32 v30, 0x10000, v30
    v_mfma_f32_16x16x32_bf16 v[156:159], a[16:19], a[116:119], v[156:159]
    ds_read_b64_tr_b16 a[248:249], v30 offset:0
    ds_read_b64_tr_b16 a[250:251], v30 offset:2048
    v_mfma_f32_16x16x32_bf16 v[156:159], a[32:35], a[120:123], v[156:159]
    ds_read_b64_tr_b16 a[12:13], v31 offset:0
    ds_read_b64_tr_b16 a[14:15], v31 offset:2048
    v_mfma_f32_16x16x32_bf16 v[156:159], a[48:51], a[124:127], v[156:159]
    ds_read_b64_tr_b16 a[28:29], v31 offset:16384
    ds_read_b64_tr_b16 a[30:31], v31 offset:18432
    v_mfma_f32_16x16x32_bf16 v[156:159], a[64:67], a[128:131], v[156:159]
    v_add_u32 v31, 0x8000, v31
    v_mfma_f32_16x16x32_bf16 v[156:159], a[240:243], a[132:135], v[156:159]
    ds_read_b64_tr_b16 a[44:45], v31 offset:32768
    ds_read_b64_tr_b16 a[46:47], v31 offset:34816
    v_mfma_f32_16x16x32_bf16 v[156:159], v[184:187], a[136:139], v[156:159]
    v_cvt_pk_bf16_f32 v118, v136, v137
    v_cvt_pk_bf16_f32 v119, v138, v139
    v_mfma_f32_16x16x32_bf16 v[156:159], v[188:191], a[140:143], v[156:159]
    buffer_store_dwordx4 v[116:119], v34, s[24:27], s39 offen offset:0 sc1
    v_mfma_f32_16x16x32_bf16 v[36:39], a[4:7], a[112:115], 0
    ds_read_b64_tr_b16 a[60:61], v31 offset:0
    ds_read_b64_tr_b16 a[62:63], v31 offset:2048
    v_mfma_f32_16x16x32_bf16 v[36:39], a[20:23], a[116:119], v[36:39]
    v_add_u32 v31, 0xffff4000, v31
    v_mfma_f32_16x16x32_bf16 v[36:39], a[36:39], a[120:123], v[36:39]
    ds_read_b64_tr_b16 a[76:77], v31 offset:0
    ds_read_b64_tr_b16 a[78:79], v31 offset:2048
    v_mfma_f32_16x16x32_bf16 v[36:39], a[52:55], a[124:127], v[36:39]
    v_add_u32 v31, 0x10000, v31
    v_mfma_f32_16x16x32_bf16 v[36:39], a[68:71], a[128:131], v[36:39]
    ds_read_b64_tr_b16 a[252:253], v31 offset:0
    ds_read_b64_tr_b16 a[254:255], v31 offset:2048
    v_mfma_f32_16x16x32_bf16 v[36:39], a[244:247], a[132:135], v[36:39]
    v_mfma_f32_16x16x32_bf16 v[36:39], v[204:207], a[136:139], v[36:39]
    buffer_atomic_add v102, v103, s[24:27], 0 offen offset:0 sc0 sc1
    v_mfma_f32_16x16x32_bf16 v[36:39], v[208:211], a[140:143], v[36:39]
    v_cvt_pk_bf16_f32 v156, v156, v157
    v_cvt_pk_bf16_f32 v157, v158, v159
    v_mfma_f32_16x16x32_bf16 v[76:79], a[0:3], a[144:147], 0
    s_mov_b32 s39, 0x58000
    v_mfma_f32_16x16x32_bf16 v[76:79], a[16:19], a[148:151], v[76:79]
    v_mfma_f32_16x16x32_bf16 v[76:79], a[32:35], a[152:155], v[76:79]
    v_mfma_f32_16x16x32_bf16 v[76:79], a[48:51], a[156:159], v[76:79]
    v_mfma_f32_16x16x32_bf16 v[76:79], a[64:67], a[160:163], v[76:79]
    v_mfma_f32_16x16x32_bf16 v[76:79], a[240:243], a[164:167], v[76:79]
    v_mfma_f32_16x16x32_bf16 v[76:79], v[184:187], a[168:171], v[76:79]
    v_cvt_pk_bf16_f32 v158, v36, v37
    v_cvt_pk_bf16_f32 v159, v38, v39
    v_mfma_f32_16x16x32_bf16 v[76:79], v[188:191], a[172:175], v[76:79]
    buffer_store_dwordx4 v[156:159], v34, s[24:27], s39 offen offset:0 sc1
    v_mfma_f32_16x16x32_bf16 v[80:83], a[4:7], a[144:147], 0
    v_mfma_f32_16x16x32_bf16 v[80:83], a[20:23], a[148:151], v[80:83]
    v_mfma_f32_16x16x32_bf16 v[80:83], a[36:39], a[152:155], v[80:83]
    v_mfma_f32_16x16x32_bf16 v[80:83], a[52:55], a[156:159], v[80:83]
    v_mfma_f32_16x16x32_bf16 v[80:83], a[68:71], a[160:163], v[80:83]
    v_mfma_f32_16x16x32_bf16 v[80:83], a[244:247], a[164:167], v[80:83]
    v_mfma_f32_16x16x32_bf16 v[80:83], v[204:207], a[168:171], v[80:83]
    v_cvt_pk_bf16_f32 v76, v76, v77
    v_cvt_pk_bf16_f32 v77, v78, v79
    v_mfma_f32_16x16x32_bf16 v[80:83], v[208:211], a[172:175], v[80:83]
    s_mov_b32 s39, 0x60000
    v_mfma_f32_16x16x32_bf16 v[84:87], a[0:3], a[176:179], 0
    v_mov_b32 v97, 1
    v_mfma_f32_16x16x32_bf16 v[84:87], a[16:19], a[180:183], v[84:87]
    v_mfma_f32_16x16x32_bf16 v[84:87], a[32:35], a[184:187], v[84:87]
    v_mfma_f32_16x16x32_bf16 v[84:87], a[48:51], a[188:191], v[84:87]
    v_mfma_f32_16x16x32_bf16 v[84:87], a[64:67], a[192:195], v[84:87]
    s_waitcnt vmcnt(3)
    buffer_store_dword v97, v96, s[24:27], 0 offen offset:0 sc1
    v_mfma_f32_16x16x32_bf16 v[84:87], a[240:243], a[196:199], v[84:87]
    v_mfma_f32_16x16x32_bf16 v[84:87], v[184:187], a[200:203], v[84:87]
    v_cvt_pk_bf16_f32 v78, v80, v81
    v_cvt_pk_bf16_f32 v79, v82, v83
    v_mfma_f32_16x16x32_bf16 v[84:87], v[188:191], a[204:207], v[84:87]
    buffer_store_dwordx4 v[76:79], v34, s[24:27], s39 offen offset:0 sc1
    v_mfma_f32_16x16x32_bf16 v[88:91], a[4:7], a[176:179], 0
    v_mfma_f32_16x16x32_bf16 v[88:91], a[20:23], a[180:183], v[88:91]
    v_mfma_f32_16x16x32_bf16 v[88:91], a[36:39], a[184:187], v[88:91]
    v_mfma_f32_16x16x32_bf16 v[88:91], a[52:55], a[188:191], v[88:91]
    v_mfma_f32_16x16x32_bf16 v[88:91], a[68:71], a[192:195], v[88:91]
    v_mfma_f32_16x16x32_bf16 v[88:91], a[244:247], a[196:199], v[88:91]
    v_mfma_f32_16x16x32_bf16 v[88:91], v[204:207], a[200:203], v[88:91]
    v_cvt_pk_bf16_f32 v84, v84, v85
    v_cvt_pk_bf16_f32 v85, v86, v87
    v_mfma_f32_16x16x32_bf16 v[88:91], v[208:211], a[204:207], v[88:91]
    s_mov_b32 s39, 0x68000
    v_mfma_f32_16x16x32_bf16 v[116:119], a[0:3], a[208:211], 0
    v_mfma_f32_16x16x32_bf16 v[116:119], a[16:19], a[212:215], v[116:119]
    v_mfma_f32_16x16x32_bf16 v[116:119], a[32:35], a[216:219], v[116:119]
    v_mfma_f32_16x16x32_bf16 v[116:119], a[48:51], a[220:223], v[116:119]
    v_mfma_f32_16x16x32_bf16 v[116:119], a[64:67], a[224:227], v[116:119]
    v_mfma_f32_16x16x32_bf16 v[116:119], a[240:243], a[228:231], v[116:119]
    v_mfma_f32_16x16x32_bf16 v[116:119], v[184:187], a[232:235], v[116:119]
    v_cvt_pk_bf16_f32 v86, v88, v89
    v_cvt_pk_bf16_f32 v87, v90, v91
    v_mfma_f32_16x16x32_bf16 v[116:119], v[188:191], a[236:239], v[116:119]
    buffer_store_dwordx4 v[84:87], v34, s[24:27], s39 offen offset:0 sc1
    v_mfma_f32_16x16x32_bf16 v[136:139], a[4:7], a[208:211], 0
    v_mfma_f32_16x16x32_bf16 v[136:139], a[20:23], a[212:215], v[136:139]
    v_mfma_f32_16x16x32_bf16 v[136:139], a[36:39], a[216:219], v[136:139]
    v_mfma_f32_16x16x32_bf16 v[136:139], a[52:55], a[220:223], v[136:139]
    v_mfma_f32_16x16x32_bf16 v[136:139], a[68:71], a[224:227], v[136:139]
    v_mfma_f32_16x16x32_bf16 v[136:139], a[244:247], a[228:231], v[136:139]
    v_mfma_f32_16x16x32_bf16 v[136:139], v[204:207], a[232:235], v[136:139]
    v_cvt_pk_bf16_f32 v116, v116, v117
    v_cvt_pk_bf16_f32 v117, v118, v119
    v_mfma_f32_16x16x32_bf16 v[136:139], v[208:211], a[236:239], v[136:139]
    s_waitcnt lgkmcnt(0)
    s_mov_b32 s39, 0x70000
    v_mfma_f32_16x16x32_bf16 v[156:159], a[8:11], a[80:83], 0
    s_waitcnt vmcnt(4)
    v_readfirstlane_b32 s46, v102
    s_nop 1
    s_add_u32 s43, s46, 0
    v_mfma_f32_16x16x32_bf16 v[156:159], a[24:27], a[84:87], v[156:159]
    s_and_b32 s43, s43, 15
    s_lshr_b32 s44, s43, 1
    s_lshl_b32 s44, s44, 15
    v_mfma_f32_16x16x32_bf16 v[156:159], a[40:43], a[88:91], v[156:159]
    s_and_b32 s45, s43, 1
    s_lshl_b32 s45, s45, 14
    s_add_u32 s44, s44, s45
    v_mfma_f32_16x16x32_bf16 v[156:159], a[56:59], a[92:95], v[156:159]
    s_add_u32 s44, s44, 0
    s_cmp_lt_u32 s43, 10
    s_cselect_b32 s44, s44, 0x40000000
    v_mfma_f32_16x16x32_bf16 v[156:159], a[72:75], a[96:99], v[156:159]
    v_add_u32 v108, s44, v98
    s_lshl_b32 s43, s43, 14
    v_mfma_f32_16x16x32_bf16 v[156:159], a[248:251], a[100:103], v[156:159]
    s_add_u32 s43, s43, 0
    v_add_u32 v112, s43, v99
    s_add_u32 s43, s46, 6
    v_mfma_f32_16x16x32_bf16 v[156:159], v[224:227], a[104:107], v[156:159]
    s_and_b32 s43, s43, 15
    v_cvt_pk_bf16_f32 v118, v136, v137
    v_cvt_pk_bf16_f32 v119, v138, v139
    v_mfma_f32_16x16x32_bf16 v[156:159], v[228:231], a[108:111], v[156:159]
    s_lshr_b32 s44, s43, 1
    buffer_store_dwordx4 v[116:119], v34, s[24:27], s39 offen offset:0 sc1
    v_mfma_f32_16x16x32_bf16 v[36:39], a[12:15], a[80:83], 0
    s_lshl_b32 s44, s44, 15
    s_and_b32 s45, s43, 1
    s_lshl_b32 s45, s45, 14
    v_mfma_f32_16x16x32_bf16 v[36:39], a[28:31], a[84:87], v[36:39]
    s_add_u32 s44, s44, s45
    s_add_u32 s44, s44, 163840
    v_mfma_f32_16x16x32_bf16 v[36:39], a[44:47], a[88:91], v[36:39]
    s_cmp_lt_u32 s43, 10
    s_cselect_b32 s44, s44, 0x40000000
    v_add_u32 v109, s44, v98
    v_mfma_f32_16x16x32_bf16 v[36:39], a[60:63], a[92:95], v[36:39]
    s_lshl_b32 s43, s43, 14
    s_add_u32 s43, s43, 64
    v_add_u32 v113, s43, v99
    v_mfma_f32_16x16x32_bf16 v[36:39], a[76:79], a[96:99], v[36:39]
    s_add_u32 s43, s46, 12
    s_and_b32 s43, s43, 15
    s_lshr_b32 s44, s43, 1
    v_mfma_f32_16x16x32_bf16 v[36:39], a[252:255], a[100:103], v[36:39]
    s_lshl_b32 s44, s44, 15
    s_and_b32 s45, s43, 1
    s_lshl_b32 s45, s45, 14
    v_mfma_f32_16x16x32_bf16 v[36:39], v[244:247], a[104:107], v[36:39]
    s_add_u32 s44, s44, s45
    v_cvt_pk_bf16_f32 v156, v156, v157
    v_cvt_pk_bf16_f32 v157, v158, v159
    v_mfma_f32_16x16x32_bf16 v[36:39], v[248:251], a[108:111], v[36:39]
    s_mov_b32 s39, 0x78000
    s_add_u32 s44, s44, 327680
    v_mfma_f32_16x16x32_bf16 v[76:79], a[8:11], a[112:115], 0
    s_cmp_lt_u32 s43, 10
    s_cselect_b32 s44, s44, 0x40000000
    v_add_u32 v110, s44, v98
    v_mfma_f32_16x16x32_bf16 v[76:79], a[24:27], a[116:119], v[76:79]
    s_lshl_b32 s43, s43, 14
    s_add_u32 s43, s43, 512
    v_add_u32 v114, s43, v99
    v_mfma_f32_16x16x32_bf16 v[76:79], a[40:43], a[120:123], v[76:79]
    s_add_u32 s43, s46, 2
    s_and_b32 s43, s43, 15
    s_lshr_b32 s44, s43, 1
    v_mfma_f32_16x16x32_bf16 v[76:79], a[56:59], a[124:127], v[76:79]
    s_lshl_b32 s44, s44, 15
    s_and_b32 s45, s43, 1
    s_lshl_b32 s45, s45, 14
    v_mfma_f32_16x16x32_bf16 v[76:79], a[72:75], a[128:131], v[76:79]
    s_add_u32 s44, s44, s45
    s_add_u32 s44, s44, 491520
    v_mfma_f32_16x16x32_bf16 v[76:79], a[248:251], a[132:135], v[76:79]
    s_cmp_lt_u32 s43, 10
    s_cselect_b32 s44, s44, 0x40000000
    v_add_u32 v111, s44, v98
    v_mfma_f32_16x16x32_bf16 v[76:79], v[224:227], a[136:139], v[76:79]
    s_lshl_b32 s43, s43, 14
    v_cvt_pk_bf16_f32 v158, v36, v37
    v_cvt_pk_bf16_f32 v159, v38, v39
    v_mfma_f32_16x16x32_bf16 v[76:79], v[228:231], a[140:143], v[76:79]
    s_add_u32 s43, s43, 576
    buffer_store_dwordx4 v[156:159], v34, s[24:27], s39 offen offset:0 sc1
    v_mfma_f32_16x16x32_bf16 v[80:83], a[12:15], a[112:115], 0
    v_add_u32 v115, s43, v99
    v_mfma_f32_16x16x32_bf16 v[80:83], a[28:31], a[116:119], v[80:83]
    v_mfma_f32_16x16x32_bf16 v[80:83], a[44:47], a[120:123], v[80:83]
    v_mfma_f32_16x16x32_bf16 v[80:83], a[60:63], a[124:127], v[80:83]
    v_mfma_f32_16x16x32_bf16 v[80:83], a[76:79], a[128:131], v[80:83]
    v_mfma_f32_16x16x32_bf16 v[80:83], a[252:255], a[132:135], v[80:83]
    v_mfma_f32_16x16x32_bf16 v[80:83], v[244:247], a[136:139], v[80:83]
    v_cvt_pk_bf16_f32 v76, v76, v77
    v_cvt_pk_bf16_f32 v77, v78, v79
    v_mfma_f32_16x16x32_bf16 v[80:83], v[248:251], a[140:143], v[80:83]
    s_mov_b32 s39, 0x80000
    v_mfma_f32_16x16x32_bf16 v[84:87], a[8:11], a[144:147], 0
    v_mfma_f32_16x16x32_bf16 v[84:87], a[24:27], a[148:151], v[84:87]
    v_mfma_f32_16x16x32_bf16 v[84:87], a[40:43], a[152:155], v[84:87]
    v_mfma_f32_16x16x32_bf16 v[84:87], a[56:59], a[156:159], v[84:87]
    v_mfma_f32_16x16x32_bf16 v[84:87], a[72:75], a[160:163], v[84:87]
    v_mfma_f32_16x16x32_bf16 v[84:87], a[248:251], a[164:167], v[84:87]
    v_mfma_f32_16x16x32_bf16 v[84:87], v[224:227], a[168:171], v[84:87]
    v_cvt_pk_bf16_f32 v78, v80, v81
    v_cvt_pk_bf16_f32 v79, v82, v83
    v_mfma_f32_16x16x32_bf16 v[84:87], v[228:231], a[172:175], v[84:87]
    buffer_store_dwordx4 v[76:79], v34, s[24:27], s39 offen offset:0 sc1
    v_mfma_f32_16x16x32_bf16 v[88:91], a[12:15], a[144:147], 0
    v_mfma_f32_16x16x32_bf16 v[88:91], a[28:31], a[148:151], v[88:91]
    v_mfma_f32_16x16x32_bf16 v[88:91], a[44:47], a[152:155], v[88:91]
    v_mfma_f32_16x16x32_bf16 v[88:91], a[60:63], a[156:159], v[88:91]
    v_mfma_f32_16x16x32_bf16 v[88:91], a[76:79], a[160:163], v[88:91]
    v_mfma_f32_16x16x32_bf16 v[88:91], a[252:255], a[164:167], v[88:91]
    v_mfma_f32_16x16x32_bf16 v[88:91], v[244:247], a[168:171], v[88:91]
    v_cvt_pk_bf16_f32 v84, v84, v85
    v_cvt_pk_bf16_f32 v85, v86, v87
    v_mfma_f32_16x16x32_bf16 v[88:91], v[248:251], a[172:175], v[88:91]
    s_mov_b32 s39, 0x88000
    v_mfma_f32_16x16x32_bf16 v[116:119], a[8:11], a[176:179], 0
    v_mfma_f32_16x16x32_bf16 v[116:119], a[24:27], a[180:183], v[116:119]
    v_mfma_f32_16x16x32_bf16 v[116:119], a[40:43], a[184:187], v[116:119]
    v_mfma_f32_16x16x32_bf16 v[116:119], a[56:59], a[188:191], v[116:119]
    v_mfma_f32_16x16x32_bf16 v[116:119], a[72:75], a[192:195], v[116:119]
    v_mfma_f32_16x16x32_bf16 v[116:119], a[248:251], a[196:199], v[116:119]
    v_mfma_f32_16x16x32_bf16 v[116:119], v[224:227], a[200:203], v[116:119]
    v_cvt_pk_bf16_f32 v86, v88, v89
    v_cvt_pk_bf16_f32 v87, v90, v91
    v_mfma_f32_16x16x32_bf16 v[116:119], v[228:231], a[204:207], v[116:119]
    buffer_store_dwordx4 v[84:87], v34, s[24:27], s39 offen offset:0 sc1
    v_mfma_f32_16x16x32_bf16 v[136:139], a[12:15], a[176:179], 0
    v_mfma_f32_16x16x32_bf16 v[136:139], a[28:31], a[180:183], v[136:139]
    v_mfma_f32_16x16x32_bf16 v[136:139], a[44:47], a[184:187], v[136:139]
    v_mfma_f32_16x16x32_bf16 v[136:139], a[60:63], a[188:191], v[136:139]
    v_mfma_f32_16x16x32_bf16 v[136:139], a[76:79], a[192:195], v[136:139]
    v_mfma_f32_16x16x32_bf16 v[136:139], a[252:255], a[196:199], v[136:139]
    v_mfma_f32_16x16x32_bf16 v[136:139], v[244:247], a[200:203], v[136:139]
    v_cvt_pk_bf16_f32 v116, v116, v117
    v_cvt_pk_bf16_f32 v117, v118, v119
    v_mfma_f32_16x16x32_bf16 v[136:139], v[248:251], a[204:207], v[136:139]
    s_mov_b32 s39, 0x90000
    v_mfma_f32_16x16x32_bf16 v[156:159], a[8:11], a[208:211], 0
    v_mfma_f32_16x16x32_bf16 v[156:159], a[24:27], a[212:215], v[156:159]
    v_mfma_f32_16x16x32_bf16 v[156:159], a[40:43], a[216:219], v[156:159]
    v_mfma_f32_16x16x32_bf16 v[156:159], a[56:59], a[220:223], v[156:159]
    v_mfma_f32_16x16x32_bf16 v[156:159], a[72:75], a[224:227], v[156:159]
    v_mfma_f32_16x16x32_bf16 v[156:159], a[248:251], a[228:231], v[156:159]
    v_mfma_f32_16x16x32_bf16 v[156:159], v[224:227], a[232:235], v[156:159]
    v_cvt_pk_bf16_f32 v118, v136, v137
    v_cvt_pk_bf16_f32 v119, v138, v139
    v_mfma_f32_16x16x32_bf16 v[156:159], v[228:231], a[236:239], v[156:159]
    buffer_store_dwordx4 v[116:119], v34, s[24:27], s39 offen offset:0 sc1
    v_mfma_f32_16x16x32_bf16 v[36:39], a[12:15], a[208:211], 0
    v_mfma_f32_16x16x32_bf16 v[36:39], a[28:31], a[212:215], v[36:39]
    v_mfma_f32_16x16x32_bf16 v[36:39], a[44:47], a[216:219], v[36:39]
    v_mfma_f32_16x16x32_bf16 v[36:39], a[60:63], a[220:223], v[36:39]
    v_mfma_f32_16x16x32_bf16 v[36:39], a[76:79], a[224:227], v[36:39]
    v_mfma_f32_16x16x32_bf16 v[36:39], a[252:255], a[228:231], v[36:39]
    v_mfma_f32_16x16x32_bf16 v[36:39], v[244:247], a[232:235], v[36:39]
    v_cvt_pk_bf16_f32 v156, v156, v157
    v_cvt_pk_bf16_f32 v157, v158, v159
    v_mfma_f32_16x16x32_bf16 v[36:39], v[248:251], a[236:239], v[36:39]
    s_mov_b32 s39, 0x98000
    s_nop 6
    v_cvt_pk_bf16_f32 v158, v36, v37
    v_cvt_pk_bf16_f32 v159, v38, v39
    buffer_store_dwordx4 v[156:159], v34, s[24:27], s39 offen offset:0 sc1
    buffer_load_dword v100, v101, s[24:27], 0 offen offset:0 sc1
    s_mov_b32 s44, 200000
    v_mov_b32 v97, 2
    s_waitcnt vmcnt(1)
    buffer_store_dword v97, v96, s[24:27], 0 offen offset:0 sc1
    s_waitcnt vmcnt(1)
L_A:
    v_cmp_ge_u32 s[18:19], 0, v100
    s_nop 1
    s_and_b32 s18, s18, s16
    s_or_b32 s18, s18, s32
    s_and_b32 s43, s18, 0xf
    s_cbranch_scc1 L_skip00
    buffer_load_dwordx4 a[0:3], v108, s[24:27], s12 offen offset:0 sc1
    buffer_load_dwordx4 a[16:19], v108, s[24:27], s12 offen offset:1024 sc1
    buffer_load_dwordx4 a[4:7], v109, s[24:27], s12 offen offset:0 sc1
    buffer_load_dwordx4 a[20:23], v109, s[24:27], s12 offen offset:1024 sc1
    s_or_b32 s32, s32, 0xf
L_skip00:
    s_and_b32 s43, s18, 0xf0
    s_cbranch_scc1 L_skip01
    buffer_load_dwordx4 a[32:35], v108, s[24:27], s13 offen offset:0 sc1
    buffer_load_dwordx4 a[48:51], v108, s[24:27], s13 offen offset:1024 sc1
    buffer_load_dwordx4 a[36:39], v109, s[24:27], s13 offen offset:0 sc1
    buffer_load_dwordx4 a[52:55], v109, s[24:27], s13 offen offset:1024 sc1
    s_or_b32 s32, s32, 0xf0
L_skip01:
    s_and_b32 s43, s18, 0xf00
    s_cbranch_scc1 L_skip02
    buffer_load_dwordx4 a[64:67], v108, s[24:27], s14 offen offset:0 sc1
    buffer_load_dwordx4 a[240:243], v108, s[24:27], s14 offen offset:1024 sc1
    buffer_load_dwordx4 a[68:71], v109, s[24:27], s14 offen offset:0 sc1
    buffer_load_dwordx4 a[244:247], v109, s[24:27], s14 offen offset:1024 sc1
    s_or_b32 s32, s32, 0xf00
L_skip02:
    s_and_b32 s43, s18, 0xf000
    s_cbranch_scc1 L_skip03
    buffer_load_dwordx4 v[184:187], v108, s[24:27], s15 offen offset:0 sc1
    buffer_load_dwordx4 v[188:191], v108, s[24:27], s15 offen offset:1024 sc1
    buffer_load_dwordx4 v[204:207], v109, s[24:27], s15 offen offset:0 sc1
    buffer_load_dwordx4 v[208:211], v109, s[24:27], s15 offen offset:1024 sc1
    s_or_b32 s32, s32, 0xf000
L_skip03:
    s_cmp_eq_u32 s32, 0xffff
    s_cbranch_scc1 L_B
    buffer_load_dword v100, v101, s[24:27], 0 offen sc1
    s_sub_u32 s44, s44, 1
    s_cbranch_scc1 L_exit
    s_waitcnt vmcnt(0)
    s_branch L_A
L_B:
    v_cmp_ge_u32 s[18:19], 1, v100
    s_nop 1
    s_and_b32 s18, s18, s16
    s_or_b32 s18, s18, s33
    s_and_b32 s43, s18, 0xf
    s_cbranch_scc1 L_skip10
    buffer_load_dwordx4 a[80:83], v110, s[24:27], s12 offen offset:0 sc1
    buffer_load_dwordx4 a[84:87], v110, s[24:27], s12 offen offset:1024 sc1
    buffer_load_dwordx4 a[112:115], v111, s[24:27], s12 offen offset:0 sc1
    buffer_load_dwordx4 a[116:119], v111, s[24:27], s12 offen offset:1024 sc1
    s_or_b32 s33, s33, 0xf
L_skip10:
    s_and_b32 s43, s18, 0xf0
    s_cbranch_scc1 L_skip11
    buffer_load_dwordx4 a[88:91], v110, s[24:27], s13 offen offset:0 sc1
    buffer_load_dwordx4 a[92:95], v110, s[24:27], s13 offen offset:1024 sc1
    buffer_load_dwordx4 a[120:123], v111, s[24:27], s13 offen offset:0 sc1
    buffer_load_dwordx4 a[124:127], v111, s[24:27], s13 offen offset:1024 sc1
    s_or_b32 s33, s33, 0xf0
L_skip11:
    s_and_b32 s43, s18, 0xf00
    s_cbranch_scc1 L_skip12
    buffer_load_dwordx4 a[96:99], v110, s[24:27], s14 offen offset:0 sc1
    buffer_load_dwordx4 a[100:103], v110, s[24:27], s14 offen offset:1024 sc1
    buffer_load_dwordx4 a[128:131], v111, s[24:27], s14 offen offset:0 sc1
    buffer_load_dwordx4 a[132:135], v111, s[24:27], s14 offen offset:1024 sc1
    s_or_b32 s33, s33, 0xf00
L_skip12:
    s_and_b32 s43, s18, 0xf000
    s_cbranch_scc1 L_skip13
    buffer_load_dwordx4 a[104:107], v110, s[24:27], s15 offen offset:0 sc1
    buffer_load_dwordx4 a[108:111], v110, s[24:27], s15 offen offset:1024 sc1
    buffer_load_dwordx4 a[136:139], v111, s[24:27], s15 offen offset:0 sc1
    buffer_load_dwordx4 a[140:143], v111, s[24:27], s15 offen offset:1024 sc1
    s_or_b32 s33, s33, 0xf000
L_skip13:
    s_cmp_eq_u32 s33, 0xffff
    s_cbranch_scc1 L_F
    buffer_load_dword v100, v101, s[24:27], 0 offen sc1
    s_sub_u32 s44, s44, 1
    s_cbranch_scc1 L_exit
    s_cmp_eq_u32 s34, 1
    s_cbranch_scc1 L_mid
    s_max_u32 s34, s34, 1
    s_waitcnt vmcnt(0)
    s_branch L_B
L_F:
    s_cmp_eq_u32 s34, 2
    s_cbranch_scc1 L_last0
    s_waitcnt vmcnt(16)
    s_mov_b32 s34, 3
L_mid:
    v_mfma_f32_16x16x32_bf16 v[76:79], v[104:107], a[0:3], 0
    v_mfma_f32_16x16x32_bf16 v[80:83], v[104:107], a[4:7], 0
    v_mfma_f32_16x16x32_bf16 v[76:79], v[104:107], a[16:19], v[76:79]
    v_mfma_f32_16x16x32_bf16 v[80:83], v[104:107], a[20:23], v[80:83]
    v_mfma_f32_16x16x32_bf16 v[76:79], v[104:107], a[32:35], v[76:79]
    v_mfma_f32_16x16x32_bf16 v[80:83], v[104:107], a[36:39], v[80:83]
    v_mfma_f32_16x16x32_bf16 v[76:79], v[104:107], a[48:51], v[76:79]
    v_mfma_f32_16x16x32_bf16 v[80:83], v[104:107], a[52:55], v[80:83]
    v_mfma_f32_16x16x32_bf16 v[76:79], v[104:107], a[64:67], v[76:79]
    v_mfma_f32_16x16x32_bf16 v[80:83], v[104:107], a[68:71], v[80:83]
    v_mfma_f32_16x16x32_bf16 v[76:79], v[104:107], a[240:243], v[76:79]
    v_mfma_f32_16x16x32_bf16 v[80:83], v[104:107], a[244:247], v[80:83]
    v_mfma_f32_16x16x32_bf16 v[76:79], v[104:107], v[184:187], v[76:79]
    v_mfma_f32_16x16x32_bf16 v[80:83], v[104:107], v[204:207], v[80:83]
    v_mfma_f32_16x16x32_bf16 v[76:79], v[104:107], v[188:191], v[76:79]
    v_mfma_f32_16x16x32_bf16 v[80:83], v[104:107], v[208:211], v[80:83]
    s_nop 6
    v_cvt_pk_bf16_f32 v76, v76, v77
    v_cvt_pk_bf16_f32 v77, v78, v79
    buffer_store_dwordx2 v[76:77], v112, s[8:11], 0 offen nt
    v_cvt_pk_bf16_f32 v80, v80, v81
    v_cvt_pk_bf16_f32 v81, v82, v83
    buffer_store_dwordx2 v[80:81], v113, s[8:11], 0 offen nt
    s_waitcnt vmcnt(2)
    s_cmp_eq_u32 s34, 3
    s_cbranch_scc1 L_last
    s_mov_b32 s34, 2
    s_branch L_B
L_last0:
    s_waitcnt vmcnt(0)
L_last:
    v_mfma_f32_16x16x32_bf16 v[84:87], v[104:107], a[80:83], 0
    v_mfma_f32_16x16x32_bf16 v[88:91], v[104:107], a[112:115], 0
    v_mfma_f32_16x16x32_bf16 v[84:87], v[104:107], a[84:87], v[84:87]
    v_mfma_f32_16x16x32_bf16 v[88:91], v[104:107], a[116:119], v[88:91]
    v_mfma_f32_16x16x32_bf16 v[84:87], v[104:107], a[88:91], v[84:87]
    v_mfma_f32_16x16x32_bf16 v[88:91], v[104:107], a[120:123], v[88:91]
    v_mfma_f32_16x16x32_bf16 v[84:87], v[104:107], a[92:95], v[84:87]
    v_mfma_f32_16x16x32_bf16 v[88:91], v[104:107], a[124:127], v[88:91]
    v_mfma_f32_16x16x32_bf16 v[84:87], v[104:107], a[96:99], v[84:87]
    v_mfma_f32_16x16x32_bf16 v[88:91], v[104:107], a[128:131], v[88:91]
    v_mfma_f32_16x16x32_bf16 v[84:87], v[104:107], a[100:103], v[84:87]
    v_mfma_f32_16x16x32_bf16 v[88:91], v[104:107], a[132:135], v[88:91]
    v_mfma_f32_16x16x32_bf16 v[84:87], v[104:107], a[104:107], v[84:87]
    v_mfma_f32_16x16x32_bf16 v[88:91], v[104:107], a[136:139], v[88:91]
    v_mfma_f32_16x16x32_bf16 v[84:87], v[104:107], a[108:111], v[84:87]
    v_mfma_f32_16x16x32_bf16 v[88:91], v[104:107], a[140:143], v[88:91]
    s_nop 6
    v_cvt_pk_bf16_f32 v84, v84, v85
    v_cvt_pk_bf16_f32 v85, v86, v87
    buffer_store_dwordx2 v[84:85], v114, s[8:11], 0 offen nt
    v_cvt_pk_bf16_f32 v88, v88, v89
    v_cvt_pk_bf16_f32 v89, v90, v91
    buffer_store_dwordx2 v[88:89], v115, s[8:11], 0 offen nt
L_exit:
    s_endpgm
L_hot_end:
L_wait_ready:
    buffer_load_dword v32, v34, s[8:11], 0 offen sc1
    s_add_u32 s83, s83, 2
    s_cmp_gt_u32 s83, 400000
    s_cbranch_scc1 L_exit
    s_waitcnt vmcnt(0)
    v_readlane_b32 s44, v32, 0
    v_readlane_b32 s80, v32, s81
    s_nop 1
    s_branch L_again
L_rerot:
    s_mov_b32 s82, s44
    s_branch L_redo
L_slow:
    s_mov_b32 s79, 1
L_redo:
    s_waitcnt vmcnt(0) lgkmcnt(0)
    s_barrier
    s_mov_b32 s83, 1
    s_lshl_b32 s43, s36, 6
    v_add_u32 v0, s43, v0
    s_branch L_restart
L_maxpass:
    s_mov_b32 s46, m0
    s_mov_b32 s47, 0
    ds_read_b128 a[80:83], v26 offset:0
    ds_read_b128 a[84:87], v26 offset:1024
    ds_read_b128 a[88:91], v26 offset:2048
    ds_read_b128 a[92:95], v26 offset:3072
    ds_read_b128 a[96:99], v26 offset:4096
    ds_read_b128 a[100:103], v26 offset:5120
    ds_read_b128 a[104:107], v26 offset:6144
    ds_read_b128 a[108:111], v26 offset:7168
    ds_read_b128 a[112:115], v26 offset:8192
    ds_read_b128 a[116:119], v26 offset:9216
    ds_read_b128 a[120:123], v34 offset:0
    ds_read_b128 a[124:127], v34 offset:1024
    ds_read_b128 a[128:131], v34 offset:2048
    ds_read_b128 a[132:135], v34 offset:3072
    ds_read_b128 a[136:139], v34 offset:4096
    ds_read_b128 a[140:143], v34 offset:5120
    ds_read_b128 a[144:147], v34 offset:6144
    ds_read_b128 a[148:151], v34 offset:7168
    ds_read_b128 a[152:155], v34 offset:8192
    ds_read_b128 a[156:159], v34 offset:9216
    v_add_u32 v124, 0xffff4000, v14
    v_add_u32 v125, 0xffff4000, v15
    v_add_u32 v126, 0xffff4000, v16
    v_add_u32 v127, 0xffff4000, v17
    v_mov_b32 v116, 0xff800000
    v_mov_b32 v117, 0xff800000
    v_mov_b32 v118, 0xff800000
    v_mov_b32 v119, 0xff800000
    v_mov_b32 v120, 0xff800000
    s_add_u32 m0, s37, 0xc000
    s_nop 0
L_max_loop:
    buffer_load_dwordx4 v4, s[12:15], s47 offen offset:0 lds
    buffer_load_dwordx4 v5, s[12:15], s47 offen offset:1024 lds
    buffer_load_dwordx4 v6, s[12:15], s47 offen offset:2048 lds
    buffer_load_dwordx4 v7, s[12:15], s47 offen offset:3072 lds
    s_waitcnt vmcnt(0)
    s_barrier
    ds_read_b128 a[184:187], v124 offset:0
    ds_read_b128 a[188:191], v125 offset:0
    ds_read_b128 a[192:195], v126 offset:0
    ds_read_b128 a[196:199], v127 offset:0
    ds_read_b128 a[200:203], v124 offset:4096
    ds_read_b128 a[204:207], v125 offset:4096
    ds_read_b128 a[208:211], v126 offset:4096
    ds_read_b128 a[212:215], v127 offset:4096
    s_waitcnt lgkmcnt(0)
    s_barrier
    v_mfma_f32_16x16x32_bf16 v[56:59], a[184:187], a[80:83], 0
    v_mfma_f32_16x16x32_bf16 v[56:59], a[188:191], a[100:103], v[56:59]
    v_mfma_f32_16x16x32_bf16 v[56:59], a[192:195], a[120:123], v[56:59]
    v_mfma_f32_16x16x32_bf16 v[56:59], a[196:199], a[140:143], v[56:59]
    v_mfma_f32_16x16x32_bf16 v[60:63], a[184:187], a[84:87], 0
    v_mfma_f32_16x16x32_bf16 v[60:63], a[188:191], a[104:107], v[60:63]
    v_mfma_f32_16x16x32_bf16 v[60:63], a[192:195], a[124:127], v[60:63]
    v_mfma_f32_16x16x32_bf16 v[60:63], a[196:199], a[144:147], v[60:63]
    v_mfma_f32_16x16x32_bf16 v[64:67], a[184:187], a[88:91], 0
    v_mfma_f32_16x16x32_bf16 v[64:67], a[188:191], a[108:111], v[64:67]
    v_mfma_f32_16x16x32_bf16 v[64:67], a[192:195], a[128:131], v[64:67]
    v_mfma_f32_16x16x32_bf16 v[64:67], a[196:199], a[148:151], v[64:67]
    v_mfma_f32_16x16x32_bf16 v[68:71], a[184:187], a[92:95], 0
    v_mfma_f32_16x16x32_bf16 v[68:71], a[188:191], a[112:115], v[68:71]
    v_mfma_f32_16x16x32_bf16 v[68:71], a[192:195], a[132:135], v[68:71]
    v_mfma_f32_16x16x32_bf16 v[68:71], a[196:199], a[152:155], v[68:71]
    v_mfma_f32_16x16x32_bf16 v[72:75], a[184:187], a[96:99], 0
    v_mfma_f32_16x16x32_bf16 v[72:75], a[188:191], a[116:119], v[72:75]
    v_mfma_f32_16x16x32_bf16 v[72:75], a[192:195], a[136:139], v[72:75]
    v_mfma_f32_16x16x32_bf16 v[72:75], a[196:199], a[156:159], v[72:75]
    v_mfma_f32_16x16x32_bf16 v[96:99], a[200:203], a[80:83], 0
    v_mfma_f32_16x16x32_bf16 v[96:99], a[204:207], a[100:103], v[96:99]
    v_mfma_f32_16x16x32_bf16 v[96:99], a[208:211], a[120:123], v[96:99]
    v_mfma_f32_16x16x32_bf16 v[96:99], a[212:215], a[140:143], v[96:99]
    v_mfma_f32_16x16x32_bf16 v[100:103], a[200:203], a[84:87], 0
    v_mfma_f32_16x16x32_bf16 v[100:103], a[204:207], a[104:107], v[100:103]
    v_mfma_f32_16x16x32_bf16 v[100:103], a[208:211], a[124:127], v[100:103]
    v_mfma_f32_16x16x32_bf16 v[100:103], a[212:215], a[144:147], v[100:103]
    v_mfma_f32_16x16x32_bf16 v[104:107], a[200:203], a[88:91], 0
    v_mfma_f32_16x16x32_bf16 v[104:107], a[204:207], a[108:111], v[104:107]
    v_mfma_f32_16x16x32_bf16 v[104:107], a[208:211], a[128:131], v[104:107]
    v_mfma_f32_16x16x32_bf16 v[104:107], a[212:215], a[148:151], v[104:107]
    v_mfma_f32_16x16x32_bf16 v[108:111], a[200:203], a[92:95], 0
    v_mfma_f32_16x16x32_bf16 v[108:111], a[204:207], a[112:115], v[108:111]
    v_mfma_f32_16x16x32_bf16 v[108:111], a[208:211], a[132:135], v[108:111]
    v_mfma_f32_16x16x32_bf16 v[108:111], a[212:215], a[152:155], v[108:111]
    v_mfma_f32_16x16x32_bf16 v[112:115], a[200:203], a[96:99], 0
    v_mfma_f32_16x16x32_bf16 v[112:115], a[204:207], a[116:119], v[112:115]
    v_mfma_f32_16x16x32_bf16 v[112:115], a[208:211], a[136:139], v[112:115]
    v_mfma_f32_16x16x32_bf16 v[112:115], a[212:215], a[156:159], v[112:115]
    v_max3_f32 v116, v116, v56, v57
    v_max3_f32 v116, v116, v58, v59
    v_max3_f32 v117, v117, v60, v61
    v_max3_f32 v117, v117, v62, v63
    v_max3_f32 v118, v118, v64, v65
    v_max3_f32 v118, v118, v66, v67
    v_max3_f32 v119, v119, v68, v69
    v_max3_f32 v119, v119, v70, v71
    v_max3_f32 v120, v120, v72, v73
    v_max3_f32 v120, v120, v74, v75
    v_max3_f32 v116, v116, v96, v97
    v_max3_f32 v116, v116, v98, v99
    v_max3_f32 v117, v117, v100, v101
    v_max3_f32 v117, v117, v102, v103
    v_max3_f32 v118, v118, v104, v105
    v_max3_f32 v118, v118, v106, v107
    v_max3_f32 v119, v119, v108, v109
    v_max3_f32 v119, v119, v110, v111
    v_max3_f32 v120, v120, v112, v113
    v_max3_f32 v120, v120, v114, v115
    s_add_u32 s47, s47, 8192
    s_cmp_lt_u32 s47, 0x10000
    s_cbranch_scc1 L_max_loop
    v_mov_b32 v130, v116
    s_nop 1
    v_permlane16_swap_b32 v130, v116
    s_nop 1
    v_max_f32 v116, v116, v130
    v_mov_b32 v130, v116
    s_nop 1
    v_permlane32_swap_b32 v130, v116
    s_nop 1
    v_max_f32 v116, v116, v130
    v_mov_b32 v130, v117
    s_nop 1
    v_permlane16_swap_b32 v130, v117
    s_nop 1
    v_max_f32 v117, v117, v130
    v_mov_b32 v130, v117
    s_nop 1
    v_permlane32_swap_b32 v130, v117
    s_nop 1
    v_max_f32 v117, v117, v130
    v_mov_b32 v130, v118
    s_nop 1
    v_permlane16_swap_b32 v130, v118
    s_nop 1
    v_max_f32 v118, v118, v130
    v_mov_b32 v130, v118
    s_nop 1
    v_permlane32_swap_b32 v130, v118
    s_nop 1
    v_max_f32 v118, v118, v130
    v_mov_b32 v130, v119
    s_nop 1
    v_permlane16_swap_b32 v130, v119
    s_nop 1
    v_max_f32 v119, v119, v130
    v_mov_b32 v130, v119
    s_nop 1
    v_permlane32_swap_b32 v130, v119
    s_nop 1
    v_max_f32 v119, v119, v130
    v_mov_b32 v130, v120
    s_nop 1
    v_permlane16_swap_b32 v130, v120
    s_nop 1
    v_max_f32 v120, v120, v130
    v_mov_b32 v130, v120
    s_nop 1
    v_permlane32_swap_b32 v130, v120
    s_nop 1
    v_max_f32 v120, v120, v130
    v_lshl_add_u32 v131, v0, 2, s37
    ds_write_b32 v131, v116 offset:49152
    ds_write_b32 v131, v117 offset:49408
    ds_write_b32 v131, v118 offset:49664
    ds_write_b32 v131, v119 offset:49920
    ds_write_b32 v131, v120 offset:50176
    v_xor_b32 v131, 0x1000, v131
    s_waitcnt lgkmcnt(0)
    s_barrier
    ds_read_b32 v132, v131 offset:49152
    ds_read_b32 v133, v131 offset:49408
    ds_read_b32 v134, v131 offset:49664
    ds_read_b32 v135, v131 offset:49920
    ds_read_b32 v136, v131 offset:50176
    s_waitcnt lgkmcnt(0)
    v_max_f32 v116, v116, v132
    v_sub_f32 v36, 0, v116
    v_sub_f32 v37, 0, v116
    v_sub_f32 v38, 0, v116
    v_sub_f32 v39, 0, v116
    v_max_f32 v117, v117, v133
    v_sub_f32 v40, 0, v117
    v_sub_f32 v41, 0, v117
    v_sub_f32 v42, 0, v117
    v_sub_f32 v43, 0, v117
    v_max_f32 v118, v118, v134
    v_sub_f32 v44, 0, v118
    v_sub_f32 v45, 0, v118
    v_sub_f32 v46, 0, v118
    v_sub_f32 v47, 0, v118
    v_max_f32 v119, v119, v135
    v_sub_f32 v48, 0, v119
    v_sub_f32 v49, 0, v119
    v_sub_f32 v50, 0, v119
    v_sub_f32 v51, 0, v119
    v_max_f32 v120, v120, v136
    v_sub_f32 v52, 0, v120
    v_sub_f32 v53, 0, v120
    v_sub_f32 v54, 0, v120
    v_sub_f32 v55, 0, v120
    s_mov_b32 m0, s46
    s_barrier
    s_branch L_att
L_code_end:
.section .rodata,"a"
.p2align 6
.amdhsa_kernel concat_heads__gqa_block_cached__gqa_block_cached__near_ridge_kernel
  .amdhsa_next_free_vgpr 512
  .amdhsa_next_free_sgpr 102
  .amdhsa_accum_offset 256
  .amdhsa_group_segment_fixed_size 0
  .amdhsa_kernarg_size 104
  .amdhsa_user_sgpr_count 2
  .amdhsa_user_sgpr_kernarg_segment_ptr 1
  .amdhsa_system_sgpr_workgroup_id_x 1
.end_amdhsa_kernel
```
